```python
import torch

def _softmax(x, axis=-1):
    return torch.softmax(x, dim=axis)
def _gelu(x):
    return torch.nn.functional.gelu(x, approximate="tanh")
def _silu(x):
    return torch.nn.functional.silu(x)
def _sigmoid(x):
    return torch.sigmoid(x)
def _layernorm(x, axis=-1, eps=1e-5):
    m = x.mean(dim=axis, keepdim=True)
    v = x.var(dim=axis, keepdim=True, unbiased=False)
    return (x - m) / torch.sqrt(v + eps)
def _scatter_add(tgt, idx, src, axis=0):
    return tgt.clone().index_add_(axis, idx, src)
def _segment_sum(src, seg, n):
    out = torch.zeros((n,) + src.shape[1:], dtype=src.dtype)
    return out.index_add_(0, seg, src)
def _pad(x, pw):
    flat = tuple(v for pair in reversed(pw) for v in pair)
    return torch.nn.functional.pad(x, flat)

kernel_name = 'concat_heads__grouped_kv_mqa__ssm_conv_s4d__prompt'

def setup_inputs():

    _w = (lambda a: (lambda t: t.to(torch.bfloat16) if t.is_floating_point() else t)(torch.as_tensor(a)))
    def _A_setup():
        B, S, D, H = 1, 2048, 640, 32
        Dh = D // H
        return {
            "x": _w((lambda *s: torch.randn(*s, dtype=torch.bfloat16) * 0.05)(B, S, D)),
            "wq": _w((lambda *s: torch.randn(*s, dtype=torch.bfloat16) * 0.8)(D, H * Dh)),
            "wk": _w((lambda *s: torch.randn(*s, dtype=torch.bfloat16) * 0.8)(D, Dh)),
            "wv": _w((lambda *s: torch.randn(*s, dtype=torch.bfloat16) * 0.05)(D, Dh)),
            "wo": _w((lambda *s: torch.randn(*s, dtype=torch.bfloat16) * 0.05)(H * Dh, D)),
        }
    _A_in = _A_setup()

    def _B_setup():
        Bsz, L, D, N = 1, 2048, 640, 128
        return {
            "u": _w((lambda *s: torch.randn(*s, dtype=torch.bfloat16) * 0.05)(Bsz, L, D)),
            "log_A_real": _w((lambda *s: torch.randn(*s, dtype=torch.bfloat16) * 6.4)(D, N) * 0.5),
            "A_imag": _w((lambda *s: torch.randn(*s, dtype=torch.bfloat16) * 0.05)(D, N) * 3.14),
            "C_real": _w((lambda *s: torch.randn(*s, dtype=torch.bfloat16) * 0.05)(D, N) / N ** 0.5),
            "C_imag": _w((lambda *s: torch.randn(*s, dtype=torch.bfloat16) * 0.05)(D, N) / N ** 0.5),
            "log_dt": _w((lambda *s: torch.randn(*s, dtype=torch.bfloat16) * 0.05)(D) * 0.5 - 4.0),
            "D_skip": _w((lambda *s: torch.randn(*s, dtype=torch.bfloat16) * 0.05)(D)),
        }
    _B_in = _B_setup()

    return {
        "A_x": _A_in["x"],
        "A_wq": _A_in["wq"],
        "A_wk": _A_in["wk"],
        "A_wv": _A_in["wv"],
        "A_wo": _A_in["wo"],
        "B_u": _B_in["u"],
        "B_log_A_real": _B_in["log_A_real"],
        "B_A_imag": _B_in["A_imag"],
        "B_C_real": _B_in["C_real"],
        "B_C_imag": _B_in["C_imag"],
        "B_log_dt": _B_in["log_dt"],
        "B_D_skip": _B_in["D_skip"],
    }

def reference(A_x, A_wq, A_wk, A_wv, A_wo, B_u, B_log_A_real, B_A_imag, B_C_real, B_C_imag, B_log_dt, B_D_skip):
    def _A_ref(x, wq, wk, wv, wo):
        B, S, D = x.shape
        H = 32
        Dh = D // H
        q = (lambda x, *d: x.permute(*d))((x @ wq).reshape(B, S, H, Dh), 0, 2, 1, 3)
        k = x @ wk
        v = x @ wv
        scores = torch.einsum("bhqd,bkd->bhqk", q, k) * (Dh ** -0.5)
        p = _softmax(scores, axis=-1)
        o = torch.einsum("bhqk,bkd->bhqd", p, v)
        return (lambda x, *d: x.permute(*d))(o, 0, 2, 1, 3).reshape(B, S, H * Dh) @ wo

    def _B_ref(u, log_A_real, A_imag, C_real, C_imag, log_dt, D_skip):
        L = u.shape[1]
        dt = torch.exp(log_dt)
        A = -torch.exp(log_A_real) + 1j * A_imag
        C = (C_real + 1j * C_imag) * dt[:, None]
        pos = (lambda x, dt: x.to(dt))(torch.arange(L), log_dt.dtype)
        P = torch.exp((A * dt[:, None])[:, :, None] * pos[None, None, :])
        K = 2.0 * torch.einsum("dn,dnl->dl", C, P).real
        L2 = 2 * L
        u_t = (lambda x, *d: x.permute(*d))(u, 0, 2, 1)
        Kf = (lambda x, *a, **k: torch.fft.rfft(x.float(), *a, **k))(K, L2)
        Uf = (lambda x, *a, **k: torch.fft.rfft(x.float(), *a, **k))(u_t, L2)
        y = (lambda x, *a, **k: torch.fft.irfft(x, *a, **k).to(torch.bfloat16))(Uf * Kf[None, :, :], L2)[:, :, :L]
        y = (lambda x, *d: x.permute(*d))(y, 0, 2, 1)
        return y + u * D_skip[None, None, :]

    a = _A_ref(A_x, A_wq, A_wk, A_wv, A_wo)
    b = _B_ref(B_u, B_log_A_real, B_A_imag, B_C_real, B_C_imag, B_log_dt, B_D_skip)
    return torch.concatenate([a, b], axis=-1)
```

```asm
; @launch grid=(256,1,1) block=(768,1,1) lds=163840
.amdgcn_target "amdgcn-amd-amdhsa--gfx950"
.text
.globl concat_heads__grouped_kv_mqa__ssm_conv_s4d__prompt_kernel
.p2align 8
.type concat_heads__grouped_kv_mqa__ssm_conv_s4d__prompt_kernel,@function
concat_heads__grouped_kv_mqa__ssm_conv_s4d__prompt_kernel:
    s_cmp_ge_u32 s2, 256
    s_cbranch_scc1 L_exit
    s_load_dwordx16 s[4:19], s[0:1], 0
    s_load_dwordx8 s[20:27], s[0:1], 64
    s_load_dwordx4 s[28:31], s[0:1], 96
    s_load_dwordx2 s[32:33], s[0:1], 112
    s_getpc_b64 s[34:35]
L_pc:
    v_lshrrev_b32 v2, 6, v0
    v_and_b32 v0, 63, v0
    v_readfirstlane_b32 s68, v2
    s_lshr_b32 s76, s2, 3
    s_and_b32 s77, s2, 7
    s_lshr_b32 s76, s2, 3
    s_cmp_lg_u32 s68, 3
    s_cbranch_scc1 L_nopf
    s_lshl_b32 s78, s76, 11
    v_and_b32 v162, 15, v0
    v_lshlrev_b32 v162, 7, v162
    v_add_u32 v162, s78, v162
    v_min_u32 v162, L_codeend-L_pc-4, v162
    global_load_dword v166, v162, s[34:35]
L_nopf:
    s_and_b32 s69, s68, 3
    s_lshr_b32 s100, s68, 2
    s_and_b32 s70, s100, 1
    s_and_b32 s78, s76, 3
    s_lshl_b32 s79, s77, 2
    s_add_u32 s71, s79, s78
    s_lshr_b32 s72, s76, 2
    s_lshl_b32 s78, s78, 1
    s_add_u32 s78, s78, s72
    s_mul_i32 s79, s78, 52
    s_lshr_b32 s79, s79, 8
    s_mul_i32 s79, s79, 5
    s_sub_u32 s73, s78, s79
    s_lshr_b32 s79, s2, 1
    s_mul_i32 s75, s79, 5
    s_and_b32 s79, s2, 1
    s_cmp_eq_u32 s79, 1
    s_cselect_b32 s74, 2, 3
    s_cselect_b32 s79, 3, 0
    s_add_u32 s75, s75, s79
    v_lshlrev_b32 v1, 4, v0
    s_cmp_eq_u32 s100, 2
    s_cbranch_scc1 L_B0
    s_cmp_lg_u32 s68, 0
    s_cbranch_scc1 L_noflaginit
    v_lshlrev_b32 v2, 2, v0
    v_add_u32 v2, 163328, v2
    v_mov_b32 v3, 0
    ds_write_b32 v2, v3
L_noflaginit:
    s_and_b32 s78, s68, 3
    s_lshl_b32 s79, s78, 2
    v_lshrrev_b32 v5, 4, v0
    v_add_u32 v6, s79, v5
    v_and_b32 v8, 15, v0
    v_xor_b32 v7, v6, v8
    v_lshlrev_b32 v7, 4, v7
    v_mul_u32_u24 v6, 1280, v6
    v_add_u32 v4, v6, v7
    s_lshr_b32 s85, s2, 3
    s_mul_i32 s85, s85, 3
    s_add_u32 s85, s85, s68
    s_cmp_ge_u32 s85, 25
    s_cselect_b32 s84, 25, 0
    s_sub_u32 s85, s85, s84
    s_cmp_ge_u32 s85, 25
    s_cselect_b32 s84, 25, 0
    s_sub_u32 s85, s85, s84
    s_cmp_ge_u32 s85, 25
    s_cselect_b32 s84, 25, 0
    s_sub_u32 s85, s85, s84
    s_cmp_ge_u32 s85, 25
    s_cselect_b32 s84, 25, 0
    s_sub_u32 s85, s85, s84
    s_lshr_b32 s80, s72, 1
    s_lshl_b32 s81, s71, 2
    s_add_u32 s80, s80, s81
    s_mul_i32 s80, s80, 20480
    s_lshl_b32 s81, s70, 8
    s_add_u32 s80, s80, s81
    s_lshl_b32 s81, s70, 12
    s_lshl_b32 s83, s78, 10
    s_add_u32 s83, s83, s81
    s_and_b32 s79, s72, 1
    s_waitcnt lgkmcnt(0)
    s_cmp_eq_u32 s79, 0
    s_cselect_b32 s44, s8, s10
    s_cselect_b32 s45, s9, s11
    s_mov_b32 s46, 25600
    s_mov_b32 s47, 0x20000
    s_mov_b32 s36, s4
    s_mov_b32 s37, s5
    s_mov_b32 s38, 2621440
    s_mov_b32 s39, 0x20000
    s_lshl_b32 s84, s85, 10
    s_add_u32 m0, s84, 81920
    s_add_u32 s85, s85, 8
    buffer_load_dwordx4 v1, s[44:47], s84 offen lds
    s_cmp_ge_u32 s85, 25
    s_cselect_b32 s84, 25, 0
    s_sub_u32 s85, s85, s84
    s_add_u32 m0, s83, 107520
    s_add_u32 s84, s80, 0
    buffer_load_dwordx4 v4, s[36:39], s84 offen lds
    s_lshl_b32 s84, s85, 10
    s_add_u32 m0, s84, 81920
    s_add_u32 s85, s85, 8
    buffer_load_dwordx4 v1, s[44:47], s84 offen lds
    s_cmp_ge_u32 s85, 25
    s_cselect_b32 s84, 25, 0
    s_sub_u32 s85, s85, s84
    s_add_u32 m0, s83, 115712
    s_add_u32 s84, s80, 512
    buffer_load_dwordx4 v4, s[36:39], s84 offen lds
    s_lshl_b32 s84, s85, 10
    s_add_u32 m0, s84, 81920
    s_add_u32 s85, s85, 8
    buffer_load_dwordx4 v1, s[44:47], s84 offen lds
    s_cmp_ge_u32 s85, 25
    s_cselect_b32 s84, 25, 0
    s_sub_u32 s85, s85, s84
    s_cmp_lg_u32 s70, 0
    s_cbranch_scc1 L_nox3
    s_add_u32 m0, s83, 123904
    s_add_u32 s84, s80, 1024
    buffer_load_dwordx4 v4, s[36:39], s84 offen lds
L_nox3:
    s_cmp_lg_u32 s68, 0
    s_cbranch_scc1 L_nowk7
    s_lshl_b32 s84, s85, 10
    s_add_u32 m0, s84, 81920
    s_add_u32 s85, s85, 8
    buffer_load_dwordx4 v1, s[44:47], s84 offen lds
L_nowk7:
    s_mov_b32 s56, s32
    s_mov_b32 s57, s33
    s_mov_b32 s58, 13631488
    s_mov_b32 s59, 0x20000
    s_mov_b32 s40, s6
    s_mov_b32 s41, s7
    s_mov_b32 s42, 819200
    s_mov_b32 s43, 0x20000
    s_barrier
    s_cmp_eq_u32 s100, 0
    s_cbranch_scc1 L_Q0
    s_setprio 1
    s_mov_b32 s76, 0
    v_mov_b32 v2, 0
    buffer_load_dword v164, v2, s[56:59], s76 offen sc1
    s_and_b32 s77, s69, 1
    s_lshl_b32 s76, s77, 5
    s_lshr_b32 s78, s69, 1
    s_mul_i32 s79, s78, 12800
    s_add_u32 s76, s76, s79
    s_add_u32 s76, s76, 81920
    v_lshrrev_b32 v2, 4, v0
    v_lshlrev_b32 v3, 3, v2
    v_bfe_u32 v4, v0, 2, 2
    v_add_u32 v3, v3, v4
    v_mul_u32_u24 v3, 40, v3
    v_and_b32 v4, 3, v0
    v_lshlrev_b32 v4, 3, v4
    v_add3_u32 v72, v3, v4, s76
    v_and_b32 v3, 15, v0
    v_xor_b32 v4, v3, v2
    v_lshlrev_b32 v4, 4, v4
    v_lshlrev_b32 v5, 8, v3
    v_add_u32 v4, v4, v5
    s_mul_i32 s79, s78, 8192
    s_add_u32 s79, s79, 107520
    s_lshl_b32 s80, s78, 7
    v_add_u32 v73, s79, v4
    v_xor_b32 v73, s80, v73
    v_xor_b32 v74, 64, v73
    v_xor_b32 v75, 0x80, v73
    v_xor_b32 v76, 0xc0, v73
    s_lshl_b32 s79, s78, 12
    v_add_u32 v78, s79, v75
    v_add_u32 v79, s79, v76
    s_lshl_b32 s76, s77, 10
    s_add_u32 s76, s76, 128000
    v_add_u32 v80, s76, v1
    s_lshl_b32 s76, s71, 1
    s_lshr_b32 s79, s72, 2
    s_add_u32 s76, s76, s79
    s_mul_i32 s76, s76, 2688
    s_add_u32 s76, s76, 73728
    s_bfe_u32 s79, s72, 0x10001
    s_and_b32 s78, s72, 1
    s_cmp_eq_u32 s78, 1
    s_cbranch_scc1 L_kva_v
    s_lshl_b32 s78, s79, 4
    v_add_u32 v3, s78, v3
    s_cmp_eq_u32 s77, 1
    s_cbranch_scc1 L_kva_k1
    v_and_b32 v4, 1, v2
    v_lshlrev_b32 v4, 5, v4
    v_add_u32 v3, v3, v4
    v_lshlrev_b32 v3, 4, v3
    v_lshrrev_b32 v4, 1, v2
    v_lshlrev_b32 v4, 3, v4
    v_add3_u32 v77, v3, v4, s76
    s_mov_b64 s[80:81], -1
    s_mov_b64 s[82:83], -1
    s_branch L_kva_done
L_kva_k1:
    v_lshlrev_b32 v3, 3, v3
    s_add_u32 s76, s76, 2432
    v_add_u32 v77, s76, v3
    s_mov_b32 s80, 0xffff
    s_mov_b32 s81, 0
    s_mov_b64 s[82:83], s[80:81]
    s_branch L_kva_done
L_kva_v:
    s_lshl_b32 s78, s77, 4
    v_add_u32 v3, s78, v3
    v_and_b32 v4, 1, v2
    v_mul_u32_u24 v4, 22, v4
    v_add_u32 v3, v3, v4
    v_lshlrev_b32 v3, 4, v3
    v_lshrrev_b32 v4, 1, v2
    v_lshlrev_b32 v4, 3, v4
    s_mul_i32 s79, s79, 704
    s_add_u32 s76, s76, s79
    s_add_u32 s76, s76, 1024
    v_add3_u32 v77, v3, v4, s76
    s_cmp_eq_u32 s77, 0
    s_cselect_b32 s80, -1, 0x003f003f
    s_mov_b32 s81, s80
    s_cselect_b32 s82, -1, 0x000f000f
    s_mov_b32 s83, s82
L_kva_done:
    v_mov_b32 v32, 0
    v_mov_b32 v33, 0
    v_mov_b32 v34, 0
    v_mov_b32 v35, 0
    s_lshl_b32 s76, s69, 2
    v_lshrrev_b32 v2, 4, v0
    v_add_u32 v2, s76, v2
    v_and_b32 v3, 15, v0
    v_xor_b32 v3, v3, v2
    v_lshlrev_b32 v3, 4, v3
    v_mul_u32_u24 v2, 1280, v2
    v_add_u32 v159, v2, v3
    v_add_u32 v2, 0, v0
    v_mul_u32_u24 v3, 0x1556, v2
    v_lshrrev_b32 v3, 16, v3
    v_mul_u32_u24 v4, 12, v3
    v_sub_u32 v4, v2, v4
    v_lshlrev_b32 v4, 4, v4
    v_mul_u32_u24 v3, 1280, v3
    v_add_u32 v160, v3, v4
    v_add_u32 v2, 64, v0
    v_mul_u32_u24 v3, 0x1556, v2
    v_lshrrev_b32 v3, 16, v3
    v_mul_u32_u24 v4, 12, v3
    v_sub_u32 v4, v2, v4
    v_lshlrev_b32 v4, 4, v4
    v_mul_u32_u24 v3, 1280, v3
    v_add_u32 v161, v3, v4
    v_add_u32 v2, 128, v0
    v_mul_u32_u24 v3, 0x1556, v2
    v_lshrrev_b32 v3, 16, v3
    v_mul_u32_u24 v4, 12, v3
    v_sub_u32 v4, v2, v4
    v_lshlrev_b32 v4, 4, v4
    v_mul_u32_u24 v3, 1280, v3
    v_add_u32 v162, v3, v4
    s_mul_i32 s88, s71, 81920
    s_mul_i32 s89, s72, 160
    s_and_b32 s89, s89, 0xffffffc0
    s_mul_i32 s76, s69, 40960
    s_add_u32 s89, s89, s76
    s_mov_b32 s98, s73
    s_add_u32 s98, s98, 1
    s_cmp_eq_u32 s98, 5
    s_cselect_b32 s98, 0, s98
    s_add_u32 s98, s98, 1
    s_cmp_eq_u32 s98, 5
    s_cselect_b32 s98, 0, s98
    s_mul_i32 s76, s70, 21504
    s_add_u32 s76, s76, 81920
    s_mul_i32 s77, s70, 21504
    s_add_u32 s77, s77, 0
    v_add_u32 v26, s76, v1
    v_add_u32 v27, s77, v1
    v_and_b32 v4, 31, v0
    v_lshlrev_b32 v5, 3, v4
    v_add_u32 v5, 2432, v5
    v_add_u32 v28, s76, v5
    v_add_u32 v29, s77, v5
    v_lshrrev_b32 v2, 5, v0
    v_min_u32 v3, 21, v4
    v_mul_u32_u24 v5, 22, v2
    v_add_u32 v3, v3, v5
    v_lshlrev_b32 v3, 4, v3
    v_add_u32 v3, 1024, v3
    v_add_u32 v30, s76, v3
    v_add_u32 v31, s77, v3
    s_mul_i32 s76, s72, 20
    s_and_b32 s77, s69, 1
    s_mul_i32 s77, s77, 10
    s_add_u32 s76, s76, s77
    s_mul_i32 s77, s70, 5
    s_add_u32 s76, s76, s77
    s_mul_i32 s77, s71, 81920
    s_lshr_b32 s78, s69, 1
    s_mul_i32 s78, s78, 40960
    s_add_u32 s77, s77, s78
    s_add_u32 s77, s77, 3145728
    v_lshrrev_b32 v5, 4, v4
    v_mul_u32_u24 v5, 20480, v5
    v_and_b32 v6, 15, v0
    v_lshlrev_b32 v6, 4, v6
    v_add_u32 v5, v5, v6
    v_add_u32 v5, s77, v5
    s_add_u32 s78, s76, 0
    v_add_u32 v6, s78, v2
    v_lshrrev_b32 v7, 3, v6
    v_lshlrev_b32 v7, 10, v7
    v_bfe_u32 v8, v6, 2, 1
    v_lshlrev_b32 v8, 9, v8
    v_add_u32 v7, v7, v8
    v_and_b32 v8, 1, v6
    v_lshlrev_b32 v8, 8, v8
    v_add_u32 v7, v7, v8
    v_bfe_u32 v8, v6, 1, 1
    v_lshlrev_b32 v8, 3, v8
    v_add3_u32 v23, v7, v8, v5
    s_add_u32 s78, s76, 2
    v_add_u32 v6, s78, v2
    v_lshrrev_b32 v7, 3, v6
    v_lshlrev_b32 v7, 10, v7
    v_bfe_u32 v8, v6, 2, 1
    v_lshlrev_b32 v8, 9, v8
    v_add_u32 v7, v7, v8
    v_and_b32 v8, 1, v6
    v_lshlrev_b32 v8, 8, v8
    v_add_u32 v7, v7, v8
    v_bfe_u32 v8, v6, 1, 1
    v_lshlrev_b32 v8, 3, v8
    v_add3_u32 v24, v7, v8, v5
    s_add_u32 s78, s76, 4
    v_mov_b32 v6, s78
    v_lshrrev_b32 v7, 3, v6
    v_lshlrev_b32 v7, 10, v7
    v_bfe_u32 v8, v6, 2, 1
    v_lshlrev_b32 v8, 9, v8
    v_add_u32 v7, v7, v8
    v_and_b32 v8, 1, v6
    v_lshlrev_b32 v8, 8, v8
    v_add_u32 v7, v7, v8
    v_bfe_u32 v8, v6, 1, 1
    v_lshlrev_b32 v8, 3, v8
    v_add3_u32 v25, v7, v8, v5
    v_cmp_gt_u32 vcc, 32, v0
    v_mov_b32 v7, 0x7fffffff
    s_nop 0
    v_cndmask_b32 v25, v7, v25, vcc
    s_mov_b32 s48, s12
    s_mov_b32 s49, s13
    s_mov_b32 s50, 819200
    s_mov_b32 s51, 0x20000
    s_mov_b32 s60, s28
    s_mov_b32 s61, s29
    s_mov_b32 s62, 5242880
    s_mov_b32 s63, 0x20000
    s_waitcnt vmcnt(0)
    v_mov_b32 v2, 163380
    v_mov_b32 v3, 1
    s_mov_b64 exec, 1
    ds_add_u32 v2, v3
    s_mov_b64 exec, -1
    v_readfirstlane_b32 s3, v164
    s_nop 1
    s_add_u32 s3, s3, 0x9e3779b8
    s_and_b32 s3, s3, 0xfffffffc
    s_mov_b32 s97, 0
    v_mov_b32 v2, 163380
L_kvin:
    ds_read_b32 v3, v2
    s_add_u32 s97, s97, 1
    s_cmp_gt_u32 s97, 0x1000000
    s_cbranch_scc1 L_kvin_done
    s_waitcnt lgkmcnt(0)
    v_cmp_gt_u32 vcc, 8, v3
    s_cbranch_vccz L_kvin_done
    s_sleep 1
    s_branch L_kvin
L_kvin_done:
    ds_read_b64_tr_b16 v[112:113], v72 offset:0
    ds_read_b64_tr_b16 v[114:115], v72 offset:160
    ds_read_b128 v[116:119], v73 offset:0
    ds_read_b64_tr_b16 v[120:121], v72 offset:1280
    ds_read_b64_tr_b16 v[122:123], v72 offset:1440
    ds_read_b128 v[124:127], v74 offset:0
    ds_read_b64_tr_b16 v[128:129], v72 offset:2560
    ds_read_b64_tr_b16 v[130:131], v72 offset:2720
    ds_read_b128 v[132:135], v78 offset:0
    ds_read_b64_tr_b16 v[136:137], v72 offset:3840
    ds_read_b64_tr_b16 v[138:139], v72 offset:4000
    ds_read_b128 v[140:143], v79 offset:0
    ds_read_b64_tr_b16 v[144:145], v72 offset:5120
    ds_read_b64_tr_b16 v[146:147], v72 offset:5280
    ds_read_b128 v[148:151], v73 offset:4096
    s_and_b32 s78, s72, 1
    s_cmp_eq_u32 s78, 1
    s_cbranch_scc1 L_kvV
    s_waitcnt lgkmcnt(12)
    v_mfma_f32_16x16x32_bf16 v[32:35], v[112:115], v[116:119], v[32:35]
    ds_read_b64_tr_b16 v[112:113], v72 offset:6400
    ds_read_b64_tr_b16 v[114:115], v72 offset:6560
    ds_read_b128 v[116:119], v74 offset:4096
    s_waitcnt lgkmcnt(12)
    v_mfma_f32_16x16x32_bf16 v[32:35], v[120:123], v[124:127], v[32:35]
    ds_read_b64_tr_b16 v[120:121], v72 offset:7680
    ds_read_b64_tr_b16 v[122:123], v72 offset:7840
    ds_read_b128 v[124:127], v78 offset:4096
    s_waitcnt lgkmcnt(12)
    v_mfma_f32_16x16x32_bf16 v[32:35], v[128:131], v[132:135], v[32:35]
    ds_read_b64_tr_b16 v[128:129], v72 offset:8960
    ds_read_b64_tr_b16 v[130:131], v72 offset:9120
    ds_read_b128 v[132:135], v79 offset:4096
    s_waitcnt lgkmcnt(12)
    v_mfma_f32_16x16x32_bf16 v[32:35], v[136:139], v[140:143], v[32:35]
    ds_read_b64_tr_b16 v[136:137], v72 offset:10240
    ds_read_b64_tr_b16 v[138:139], v72 offset:10400
    ds_read_b128 v[140:143], v73 offset:8192
    s_waitcnt lgkmcnt(12)
    v_mfma_f32_16x16x32_bf16 v[32:35], v[144:147], v[148:151], v[32:35]
    ds_read_b64_tr_b16 v[144:145], v72 offset:11520
    ds_read_b64_tr_b16 v[146:147], v72 offset:11680
    ds_read_b128 v[148:151], v74 offset:8192
    s_waitcnt lgkmcnt(12)
    v_mfma_f32_16x16x32_bf16 v[32:35], v[112:115], v[116:119], v[32:35]
    s_waitcnt lgkmcnt(9)
    v_mfma_f32_16x16x32_bf16 v[32:35], v[120:123], v[124:127], v[32:35]
    s_waitcnt lgkmcnt(6)
    v_mfma_f32_16x16x32_bf16 v[32:35], v[128:131], v[132:135], v[32:35]
    s_waitcnt lgkmcnt(3)
    v_mfma_f32_16x16x32_bf16 v[32:35], v[136:139], v[140:143], v[32:35]
    s_waitcnt lgkmcnt(0)
    v_mfma_f32_16x16x32_bf16 v[32:35], v[144:147], v[148:151], v[32:35]
    s_branch L_kvE
L_kvV:
    s_waitcnt lgkmcnt(12)
    v_mfma_f32_16x16x32_bf16 v[32:35], v[116:119], v[112:115], v[32:35]
    ds_read_b64_tr_b16 v[112:113], v72 offset:6400
    ds_read_b64_tr_b16 v[114:115], v72 offset:6560
    ds_read_b128 v[116:119], v74 offset:4096
    s_waitcnt lgkmcnt(12)
    v_mfma_f32_16x16x32_bf16 v[32:35], v[124:127], v[120:123], v[32:35]
    ds_read_b64_tr_b16 v[120:121], v72 offset:7680
    ds_read_b64_tr_b16 v[122:123], v72 offset:7840
    ds_read_b128 v[124:127], v78 offset:4096
    s_waitcnt lgkmcnt(12)
    v_mfma_f32_16x16x32_bf16 v[32:35], v[132:135], v[128:131], v[32:35]
    ds_read_b64_tr_b16 v[128:129], v72 offset:8960
    ds_read_b64_tr_b16 v[130:131], v72 offset:9120
    ds_read_b128 v[132:135], v79 offset:4096
    s_waitcnt lgkmcnt(12)
    v_mfma_f32_16x16x32_bf16 v[32:35], v[140:143], v[136:139], v[32:35]
    ds_read_b64_tr_b16 v[136:137], v72 offset:10240
    ds_read_b64_tr_b16 v[138:139], v72 offset:10400
    ds_read_b128 v[140:143], v73 offset:8192
    s_waitcnt lgkmcnt(12)
    v_mfma_f32_16x16x32_bf16 v[32:35], v[148:151], v[144:147], v[32:35]
    ds_read_b64_tr_b16 v[144:145], v72 offset:11520
    ds_read_b64_tr_b16 v[146:147], v72 offset:11680
    ds_read_b128 v[148:151], v74 offset:8192
    s_waitcnt lgkmcnt(12)
    v_mfma_f32_16x16x32_bf16 v[32:35], v[116:119], v[112:115], v[32:35]
    s_waitcnt lgkmcnt(9)
    v_mfma_f32_16x16x32_bf16 v[32:35], v[124:127], v[120:123], v[32:35]
    s_waitcnt lgkmcnt(6)
    v_mfma_f32_16x16x32_bf16 v[32:35], v[132:135], v[128:131], v[32:35]
    s_waitcnt lgkmcnt(3)
    v_mfma_f32_16x16x32_bf16 v[32:35], v[140:143], v[136:139], v[32:35]
    s_waitcnt lgkmcnt(0)
    v_mfma_f32_16x16x32_bf16 v[32:35], v[148:151], v[144:147], v[32:35]
L_kvE:
    v_mov_b32 v2, 163384
    v_mov_b32 v3, 1
    s_mov_b64 exec, 1
    ds_add_u32 v2, v3
    s_mov_b64 exec, -1
    s_cmp_lt_u32 s69, 2
    s_cbranch_scc1 L_kv_low
    s_nop 2
    ds_write_b128 v80, v[32:35]
    s_waitcnt lgkmcnt(0)
    v_mov_b32 v2, 163420
    v_mov_b32 v3, 1
    s_mov_b64 exec, 1
    ds_add_u32 v2, v3
    s_mov_b64 exec, -1
    s_branch L_kv_end
L_kv_low:
    s_mov_b32 s97, 0
    v_mov_b32 v2, 163420
L_kred:
    ds_read_b32 v3, v2
    s_add_u32 s97, s97, 1
    s_cmp_gt_u32 s97, 0x1000000
    s_cbranch_scc1 L_kred_done
    s_waitcnt lgkmcnt(0)
    v_cmp_gt_u32 vcc, 2, v3
    s_cbranch_vccz L_kred_done
    s_branch L_kred
L_kred_done:
    ds_read_b128 v[36:39], v80
    s_and_b32 s78, s72, 1
    s_cmp_eq_u32 s78, 0
    s_cselect_b32 s84, 0x3ea52b5c, 1.0
    v_and_b32 v2, 15, v0
    v_cmp_eq_u32 vcc, 4, v2
    v_mov_b32 v3, 0x3f803f80
    s_lshl_b32 s78, s78, 1
    s_add_u32 s78, s78, s69
    v_cndmask_b32 v3, 0, v3, vcc
    s_waitcnt lgkmcnt(0)
    v_add_f32 v32, v32, v36
    v_add_f32 v33, v33, v37
    v_add_f32 v34, v34, v38
    v_add_f32 v35, v35, v39
    v_mul_f32 v32, s84, v32
    v_mul_f32 v33, s84, v33
    v_mul_f32 v34, s84, v34
    v_mul_f32 v35, s84, v35
    v_cvt_pk_bf16_f32 v40, v32, v33
    v_cvt_pk_bf16_f32 v41, v34, v35
    v_mul_f32 v42, v32, v32
    v_cndmask_b32 v40, v3, v40, s[82:83]
    v_cndmask_b32 v41, v3, v41, s[82:83]
    s_mov_b64 exec, s[80:81]
    buffer_store_dwordx2 v[40:41], v77, s[56:59], 0 offen sc1
    s_mov_b64 exec, -1
    v_fmac_f32 v42, v33, v33
    v_fmac_f32 v42, v34, v34
    v_fmac_f32 v42, v35, v35
    v_cndmask_b32 v42, 0, v42, s[82:83]
    v_mov_b32 v43, v42
    s_nop 1
    v_permlane32_swap_b32 v42, v43
    s_nop 1
    v_add_f32 v42, v42, v43
    v_mov_b32 v43, v42
    s_nop 1
    v_permlane16_swap_b32 v42, v43
    s_nop 1
    v_add_f32 v42, v42, v43
    s_nop 1
    v_max_u32_dpp v42, v42, v42 row_ror:1 row_mask:0xf bank_mask:0xf
    s_nop 1
    v_max_u32_dpp v42, v42, v42 row_ror:2 row_mask:0xf bank_mask:0xf
    s_nop 1
    v_max_u32_dpp v42, v42, v42 row_ror:4 row_mask:0xf bank_mask:0xf
    s_nop 1
    v_max_u32_dpp v42, v42, v42 row_ror:8 row_mask:0xf bank_mask:0xf
    s_lshl_b32 s76, s78, 2
    s_add_u32 s76, s76, 163456
    v_mov_b32 v2, s76
    s_mov_b64 exec, 1
    ds_write_b32 v2, v42
    v_mov_b32 v2, 0
    s_cmp_lg_u32 s69, 1
    s_cbranch_scc1 L_noofr
    s_lshl_b32 s76, s71, 6
    s_lshl_b32 s77, s72, 2
    s_add_u32 s76, s76, s77
    s_add_u32 s76, s76, 4096
    s_getreg_b32 s77, hwreg(HW_REG_XCC_ID)
    s_and_b32 s77, s77, 0x7fffffff
    v_mov_b32 v3, s77
    buffer_store_dword v3, v2, s[56:59], s76 offen sc1
L_noofr:
    s_mov_b64 exec, -1
L_kv_end:
    s_waitcnt vmcnt(0)
    s_waitcnt lgkmcnt(0)
    v_mov_b32 v2, 163348
    v_mov_b32 v3, 1
    s_mov_b64 exec, 1
    ds_add_u32 v2, v3
    s_mov_b64 exec, -1
    s_add_u32 s98, s98, 1
    s_cmp_eq_u32 s98, 5
    s_cselect_b32 s98, 0, s98
    s_mov_b32 s97, 0
    v_mov_b32 v2, 163392
L_c0:
    ds_read_b32 v3, v2
    s_add_u32 s97, s97, 1
    s_cmp_gt_u32 s97, 0x1000000
    s_cbranch_scc1 L_c0_done
    s_waitcnt lgkmcnt(0)
    v_cmp_gt_u32 vcc, 4, v3
    s_cbranch_vccz L_c0_done
    s_sleep 1
    s_branch L_c0
L_c0_done:
    s_lshl_b32 s86, s98, 8
    s_add_u32 s86, s86, s88
    s_mul_i32 s87, s98, 163840
    s_add_u32 s87, s87, s89
    s_lshl_b32 s90, s69, 10
    s_mul_i32 s91, s69, 6144
    s_add_u32 s98, s98, 1
    s_cmp_eq_u32 s98, 5
    s_cselect_b32 s98, 0, s98
    s_add_u32 m0, s90, 0
    s_add_u32 s84, s86, 0
    buffer_load_dwordx4 v159, s[36:39], s84 offen lds
    s_add_u32 m0, s90, 4096
    s_add_u32 s84, s86, 20480
    buffer_load_dwordx4 v159, s[36:39], s84 offen lds
    s_add_u32 m0, s90, 8192
    s_add_u32 s84, s86, 40960
    buffer_load_dwordx4 v159, s[36:39], s84 offen lds
    s_add_u32 m0, s90, 12288
    s_add_u32 s84, s86, 61440
    buffer_load_dwordx4 v159, s[36:39], s84 offen lds
    s_add_u32 m0, s91, 16384
    s_add_u32 s84, s87, 0
    buffer_load_dwordx4 v160, s[40:43], s84 offen lds
    s_add_u32 m0, s91, 17408
    s_add_u32 s84, s87, 0
    buffer_load_dwordx4 v161, s[40:43], s84 offen lds
    s_add_u32 m0, s91, 18432
    s_add_u32 s84, s87, 0
    buffer_load_dwordx4 v162, s[40:43], s84 offen lds
    s_add_u32 m0, s91, 19456
    s_add_u32 s84, s87, 20480
    buffer_load_dwordx4 v160, s[40:43], s84 offen lds
    s_add_u32 m0, s91, 20480
    s_add_u32 s84, s87, 20480
    buffer_load_dwordx4 v161, s[40:43], s84 offen lds
    s_add_u32 m0, s91, 21504
    s_add_u32 s84, s87, 20480
    buffer_load_dwordx4 v162, s[40:43], s84 offen lds
    s_mov_b32 s97, 0
    v_mov_b32 v2, 163396
L_c1:
    ds_read_b32 v3, v2
    s_add_u32 s97, s97, 1
    s_cmp_gt_u32 s97, 0x1000000
    s_cbranch_scc1 L_c1_done
    s_waitcnt lgkmcnt(0)
    v_cmp_gt_u32 vcc, 4, v3
    s_cbranch_vccz L_c1_done
    s_sleep 1
    s_branch L_c1
L_c1_done:
    s_lshl_b32 s86, s98, 8
    s_add_u32 s86, s86, s88
    s_mul_i32 s87, s98, 163840
    s_add_u32 s87, s87, s89
    s_lshl_b32 s90, s69, 10
    s_mul_i32 s91, s69, 6144
    s_add_u32 s98, s98, 1
    s_cmp_eq_u32 s98, 5
    s_cselect_b32 s98, 0, s98
    s_add_u32 m0, s90, 40960
    s_add_u32 s84, s86, 0
    buffer_load_dwordx4 v159, s[36:39], s84 offen lds
    s_add_u32 m0, s90, 45056
    s_add_u32 s84, s86, 20480
    buffer_load_dwordx4 v159, s[36:39], s84 offen lds
    s_add_u32 m0, s90, 49152
    s_add_u32 s84, s86, 40960
    buffer_load_dwordx4 v159, s[36:39], s84 offen lds
    s_add_u32 m0, s90, 53248
    s_add_u32 s84, s86, 61440
    buffer_load_dwordx4 v159, s[36:39], s84 offen lds
    s_add_u32 m0, s91, 57344
    s_add_u32 s84, s87, 0
    buffer_load_dwordx4 v160, s[40:43], s84 offen lds
    s_add_u32 m0, s91, 58368
    s_add_u32 s84, s87, 0
    buffer_load_dwordx4 v161, s[40:43], s84 offen lds
    s_add_u32 m0, s91, 59392
    s_add_u32 s84, s87, 0
    buffer_load_dwordx4 v162, s[40:43], s84 offen lds
    s_add_u32 m0, s91, 60416
    s_add_u32 s84, s87, 20480
    buffer_load_dwordx4 v160, s[40:43], s84 offen lds
    s_add_u32 m0, s91, 61440
    s_add_u32 s84, s87, 20480
    buffer_load_dwordx4 v161, s[40:43], s84 offen lds
    s_add_u32 m0, s91, 62464
    s_add_u32 s84, s87, 20480
    buffer_load_dwordx4 v162, s[40:43], s84 offen lds
    s_cmp_lg_u32 s69, 0
    s_cbranch_scc1 L_k_wait
    s_mov_b32 s76, 40960
    v_lshlrev_b32 v56, 6, v0
    s_mov_b32 s97, 0
    s_add_u32 s77, s76, 0
    buffer_load_dword v48, v56, s[56:59], s77 offen sc1
    s_add_u32 s77, s76, 4096
    buffer_load_dword v49, v56, s[56:59], s77 offen sc1
    s_add_u32 s77, s76, 8192
    buffer_load_dword v50, v56, s[56:59], s77 offen sc1
    s_add_u32 s77, s76, 12288
    buffer_load_dword v51, v56, s[56:59], s77 offen sc1
    s_waitcnt vmcnt(14)
    v_mov_b32 v2, 163372
    v_mov_b32 v3, 1
    s_mov_b64 exec, 1
    ds_add_u32 v2, v3
    s_mov_b64 exec, -1
    s_waitcnt vmcnt(4)
    v_mov_b32 v2, 163376
    v_mov_b32 v3, 1
    s_mov_b64 exec, 1
    ds_add_u32 v2, v3
    s_mov_b64 exec, -1
    s_branch L_poll1_chk
L_poll1:
    s_add_u32 s77, s76, 0
    buffer_load_dword v48, v56, s[56:59], s77 offen sc1
    s_add_u32 s77, s76, 4096
    buffer_load_dword v49, v56, s[56:59], s77 offen sc1
    s_add_u32 s77, s76, 8192
    buffer_load_dword v50, v56, s[56:59], s77 offen sc1
    s_add_u32 s77, s76, 12288
    buffer_load_dword v51, v56, s[56:59], s77 offen sc1
L_poll1_chk:
    s_add_u32 s97, s97, 1
    s_cmp_gt_u32 s97, 0x40000
    s_cbranch_scc1 L_poll1_done
    s_waitcnt vmcnt(0)
    v_xor_b32 v52, s3, v48
    v_xor_b32 v53, s3, v49
    v_xor_b32 v54, s3, v50
    v_xor_b32 v55, s3, v51
    v_max3_u32 v52, v52, v53, v54
    v_max_u32 v52, v52, v55
    v_cmp_lt_u32 vcc, 3, v52
    s_cbranch_vccz L_poll1_done
    s_sleep 2
    s_branch L_poll1
L_poll1_done:
    v_cmp_le_u32 s[78:79], 1, v52
    v_cmp_le_u32 s[80:81], 2, v52
    v_cmp_le_u32 s[82:83], 3, v52
    s_mov_b32 s77, 0x438e0ba3
    s_nop 0
    s_cmp_lg_u64 s[78:79], 0
    s_cselect_b32 s77, 0x420e0ba3, s77
    s_cmp_lg_u64 s[80:81], 0
    s_cselect_b32 s77, 0x408e0ba3, s77
    s_cmp_lg_u64 s[82:83], 0
    s_cselect_b32 s77, 0xbf800000, s77
    s_cmp_lg_u32 s2, 0
    s_cbranch_scc1 L_noslot
    s_mov_b32 s78, 0
    v_mov_b32 v2, 0
    v_mov_b32 v3, s3
    s_mov_b64 exec, 1
    buffer_store_dword v3, v2, s[56:59], s78 offen sc1
    s_mov_b64 exec, -1
L_noslot:
    v_mov_b32 v2, 163072
    v_mov_b32 v3, s77
    v_mov_b32 v4, s3
    ds_write2_b32 v2, v3, v4 offset0:0 offset1:2
    v_mov_b32 v2, 163332
    v_mov_b32 v3, 1
    ds_write_b32 v2, v3
    s_branch L_k_go
L_k_wait:
    s_waitcnt vmcnt(10)
    v_mov_b32 v2, 163372
    v_mov_b32 v3, 1
    s_mov_b64 exec, 1
    ds_add_u32 v2, v3
    s_mov_b64 exec, -1
    s_waitcnt vmcnt(0)
    v_mov_b32 v2, 163376
    v_mov_b32 v3, 1
    s_mov_b64 exec, 1
    ds_add_u32 v2, v3
    s_mov_b64 exec, -1
    s_mov_b32 s97, 0
    v_mov_b32 v2, 163332
L_spin1:
    ds_read_b32 v3, v2
    s_add_u32 s97, s97, 1
    s_cmp_gt_u32 s97, 0x1000000
    s_cbranch_scc1 L_spin1_done
    s_waitcnt lgkmcnt(0)
    v_cmp_gt_u32 vcc, 1, v3
    s_cbranch_vccz L_spin1_done
    s_branch L_spin1
L_spin1_done:
L_k_go:
    s_mov_b32 s97, 0
    v_mov_b32 v2, 163400
L_c2:
    ds_read_b32 v3, v2
    s_add_u32 s97, s97, 1
    s_cmp_gt_u32 s97, 0x1000000
    s_cbranch_scc1 L_c2_done
    s_waitcnt lgkmcnt(0)
    v_cmp_gt_u32 vcc, 4, v3
    s_cbranch_vccz L_c2_done
    s_branch L_c2
L_c2_done:
    s_lshl_b32 s76, s71, 6
    s_add_u32 s76, s76, 4096
    v_and_b32 v2, 7, v0
    v_lshlrev_b32 v2, 2, v2
    buffer_load_dword v48, v2, s[56:59], s76 offen sc1
    s_add_u32 s84, s69, 0
    s_lshl_b32 s84, s84, 10
    s_add_u32 m0, s84, 81920
    s_add_u32 s84, s84, 73728
    buffer_load_dwordx4 v1, s[56:59], s84 offen sc1 lds
    s_add_u32 s84, s69, 4
    s_lshl_b32 s84, s84, 10
    s_add_u32 m0, s84, 81920
    s_add_u32 s84, s84, 73728
    buffer_load_dwordx4 v1, s[56:59], s84 offen sc1 lds
    s_add_u32 s84, s69, 8
    s_lshl_b32 s84, s84, 10
    s_add_u32 m0, s84, 81920
    s_add_u32 s84, s84, 73728
    buffer_load_dwordx4 v1, s[56:59], s84 offen sc1 lds
    s_add_u32 s84, s69, 12
    s_lshl_b32 s84, s84, 10
    s_add_u32 m0, s84, 81920
    s_add_u32 s84, s84, 73728
    buffer_load_dwordx4 v1, s[56:59], s84 offen sc1 lds
    s_add_u32 s84, s69, 16
    s_lshl_b32 s84, s84, 10
    s_add_u32 m0, s84, 81920
    s_add_u32 s84, s84, 73728
    buffer_load_dwordx4 v1, s[56:59], s84 offen sc1 lds
    s_add_u32 s84, s69, 20
    s_cmp_ge_u32 s84, 21
    s_cselect_b32 s85, 64512, 0
    s_lshl_b32 s84, s84, 10
    s_add_u32 m0, s84, 81920
    s_add_u32 s84, s84, s85
    s_add_u32 s84, s84, 73728
    buffer_load_dwordx4 v1, s[56:59], s84 offen sc1 lds
    s_add_u32 s84, s69, 24
    s_lshl_b32 s84, s84, 10
    s_add_u32 m0, s84, 81920
    s_add_u32 s84, s84, 138240
    buffer_load_dwordx4 v1, s[56:59], s84 offen sc1 lds
    s_add_u32 s84, s69, 28
    s_lshl_b32 s84, s84, 10
    s_add_u32 m0, s84, 81920
    s_add_u32 s84, s84, 138240
    buffer_load_dwordx4 v1, s[56:59], s84 offen sc1 lds
    s_add_u32 s84, s69, 32
    s_lshl_b32 s84, s84, 10
    s_add_u32 m0, s84, 81920
    s_add_u32 s84, s84, 138240
    buffer_load_dwordx4 v1, s[56:59], s84 offen sc1 lds
    s_add_u32 s84, s69, 36
    s_lshl_b32 s84, s84, 10
    s_add_u32 m0, s84, 81920
    s_add_u32 s84, s84, 138240
    buffer_load_dwordx4 v1, s[56:59], s84 offen sc1 lds
    s_add_u32 s84, s69, 40
    s_min_u32 s84, s84, 41
    s_lshl_b32 s84, s84, 10
    s_add_u32 m0, s84, 81920
    s_add_u32 s84, s84, 138240
    buffer_load_dwordx4 v1, s[56:59], s84 offen sc1 lds
    s_mul_i32 s76, s70, 20480
    s_add_u32 s76, s76, 81920
    s_mul_i32 s77, s70, 30720
    s_add_u32 s77, s77, 43008
    s_mul_i32 s78, s70, 76800
    s_add_u32 s78, s78, 48128
    v_lshrrev_b32 v2, 5, v0
    v_lshlrev_b32 v2, 4, v2
    v_bfe_u32 v3, v0, 4, 1
    v_lshlrev_b32 v3, 2, v3
    v_bfe_u32 v4, v0, 2, 2
    v_add3_u32 v2, v2, v3, v4
    v_mul_u32_u24 v2, 160, v2
    v_and_b32 v3, 3, v0
    v_lshlrev_b32 v3, 3, v3
    v_add3_u32 v156, v2, v3, s76
    v_add3_u32 v157, v2, v3, s77
    v_add3_u32 v158, v2, v3, s78
    s_mul_i32 s76, s71, 81920
    s_mul_i32 s77, s69, 20480
    s_add_u32 s76, s76, s77
    s_mul_i32 s77, s70, 10240
    s_add_u32 s76, s76, s77
    s_add_u32 s76, s76, 3145728
    v_add_u32 v159, s76, v1
    s_lshl_b32 s76, s69, 4
    v_and_b32 v2, 15, v0
    v_add_u32 v2, s76, v2
    v_mul_u32_u24 v2, 160, v2
    v_lshrrev_b32 v3, 4, v0
    v_lshlrev_b32 v3, 3, v3
    v_add_u32 v2, v2, v3
    v_add_u32 v160, 24576, v2
    s_mul_i32 s76, s68, 960
    s_add_u32 s76, s76, 24576
    v_add_u32 v161, s76, v1
    v_mul_u32_u24 v2, 0x199a, v0
    v_lshrrev_b32 v2, 16, v2
    v_mul_u32_u24 v3, 10, v2
    v_sub_u32 v3, v0, v3
    v_lshlrev_b32 v3, 4, v3
    v_mul_u32_u24 v2, 2560, v2
    v_add_u32 v162, v2, v3
    v_lshrrev_b32 v2, 2, v0
    v_and_b32 v2, 3, v2
    s_lshl_b32 s76, s70, 2
    v_add_u32 v2, s76, v2
    v_lshlrev_b32 v2, 3, v2
    v_and_b32 v3, 1, v0
    v_bfe_u32 v4, v0, 1, 1
    v_lshlrev_b32 v4, 2, v4
    v_add3_u32 v2, v2, v3, v4
    s_and_b32 s76, s69, 2
    v_add_u32 v2, s76, v2
    v_lshlrev_b32 v163, 2, v2
    s_mul_i32 s76, s68, 3072
    s_add_u32 s76, s76, 0
    v_add_u32 v164, s76, v1
    s_xor_b32 s77, s68, 4
    s_mul_i32 s77, s77, 3072
    s_add_u32 s77, s77, 0
    v_add_u32 v165, s77, v1
    s_waitcnt vmcnt(11)
    s_getreg_b32 s77, hwreg(HW_REG_XCC_ID)
    s_and_b32 s77, s77, 0x7fffffff
    v_and_b32 v48, 0x7fffffff, v48
    v_cmp_ne_u32 vcc, s77, v48
    v_mov_b32 v2, 163076
    s_nop 0
    s_cmp_eq_u64 vcc, 0
    s_cselect_b32 s77, 1, 0
    v_mov_b32 v3, s77
    ds_write_b32 v2, v3
    s_waitcnt vmcnt(0) lgkmcnt(0)
    v_mov_b32 v2, 163416
    v_mov_b32 v3, 1
    s_mov_b64 exec, 1
    ds_add_u32 v2, v3
    s_mov_b64 exec, -1
    s_mov_b32 s97, 0
    v_mov_b32 v2, 163416
L_goK:
    ds_read_b32 v3, v2
    s_add_u32 s97, s97, 1
    s_cmp_gt_u32 s97, 0x1000000
    s_cbranch_scc1 L_goK_done
    s_waitcnt lgkmcnt(0)
    v_cmp_gt_u32 vcc, 8, v3
    s_cbranch_vccz L_goK_done
    s_branch L_goK
L_goK_done:
    s_mul_i32 s76, s69, 3072
    s_add_u32 s76, s76, 124928
    v_add_u32 v2, s76, v1
    ds_read_b128 v[10:13], v2
    ds_read_b128 v[14:17], v2 offset:1024
    ds_read_b128 v[18:21], v2 offset:2048
    s_branch L_A1
L_Q0:
    v_mov_b32 v163, 0
    s_lshl_b32 s76, s69, 2
    v_lshrrev_b32 v2, 4, v0
    v_add_u32 v2, s76, v2
    v_and_b32 v3, 15, v0
    v_xor_b32 v3, v3, v2
    v_lshlrev_b32 v3, 4, v3
    v_mul_u32_u24 v2, 1280, v2
    v_add_u32 v159, v2, v3
    v_add_u32 v2, 0, v0
    v_mul_u32_u24 v3, 0x1556, v2
    v_lshrrev_b32 v3, 16, v3
    v_mul_u32_u24 v4, 12, v3
    v_sub_u32 v4, v2, v4
    v_lshlrev_b32 v4, 4, v4
    v_mul_u32_u24 v3, 1280, v3
    v_add_u32 v160, v3, v4
    v_add_u32 v2, 64, v0
    v_mul_u32_u24 v3, 0x1556, v2
    v_lshrrev_b32 v3, 16, v3
    v_mul_u32_u24 v4, 12, v3
    v_sub_u32 v4, v2, v4
    v_lshlrev_b32 v4, 4, v4
    v_mul_u32_u24 v3, 1280, v3
    v_add_u32 v161, v3, v4
    v_add_u32 v2, 128, v0
    v_mul_u32_u24 v3, 0x1556, v2
    v_lshrrev_b32 v3, 16, v3
    v_mul_u32_u24 v4, 12, v3
    v_sub_u32 v4, v2, v4
    v_lshlrev_b32 v4, 4, v4
    v_mul_u32_u24 v3, 1280, v3
    v_add_u32 v162, v3, v4
    s_mul_i32 s88, s71, 81920
    s_mul_i32 s89, s72, 160
    s_and_b32 s89, s89, 0xffffffc0
    s_mul_i32 s76, s69, 40960
    s_add_u32 s89, s89, s76
    s_mov_b32 s98, s73
    s_lshl_b32 s86, s98, 8
    s_add_u32 s86, s86, s88
    s_mul_i32 s87, s98, 163840
    s_add_u32 s87, s87, s89
    s_lshl_b32 s90, s69, 10
    s_mul_i32 s91, s69, 6144
    s_add_u32 s98, s98, 1
    s_cmp_eq_u32 s98, 5
    s_cselect_b32 s98, 0, s98
    s_add_u32 m0, s90, 0
    s_add_u32 s84, s86, 0
    buffer_load_dwordx4 v159, s[36:39], s84 offen lds
    s_add_u32 m0, s90, 4096
    s_add_u32 s84, s86, 20480
    buffer_load_dwordx4 v159, s[36:39], s84 offen lds
    s_add_u32 m0, s90, 8192
    s_add_u32 s84, s86, 40960
    buffer_load_dwordx4 v159, s[36:39], s84 offen lds
    s_add_u32 m0, s90, 12288
    s_add_u32 s84, s86, 61440
    buffer_load_dwordx4 v159, s[36:39], s84 offen lds
    s_add_u32 m0, s91, 16384
    s_add_u32 s84, s87, 0
    buffer_load_dwordx4 v160, s[40:43], s84 offen lds
    s_add_u32 m0, s91, 17408
    s_add_u32 s84, s87, 0
    buffer_load_dwordx4 v161, s[40:43], s84 offen lds
    s_add_u32 m0, s91, 18432
    s_add_u32 s84, s87, 0
    buffer_load_dwordx4 v162, s[40:43], s84 offen lds
    s_add_u32 m0, s91, 19456
    s_add_u32 s84, s87, 20480
    buffer_load_dwordx4 v160, s[40:43], s84 offen lds
    s_add_u32 m0, s91, 20480
    s_add_u32 s84, s87, 20480
    buffer_load_dwordx4 v161, s[40:43], s84 offen lds
    s_add_u32 m0, s91, 21504
    s_add_u32 s84, s87, 20480
    buffer_load_dwordx4 v162, s[40:43], s84 offen lds
    s_lshr_b32 s76, s69, 1
    s_lshl_b32 s76, s76, 5
    v_and_b32 v2, 31, v0
    v_add_u32 v2, s76, v2
    v_lshrrev_b32 v3, 5, v0
    v_and_b32 v4, 15, v2
    v_xor_b32 v4, v4, v3
    v_lshlrev_b32 v4, 4, v4
    v_lshlrev_b32 v2, 8, v2
    v_add_u32 v112, v2, v4
    v_xor_b32 v113, 32, v112
    v_xor_b32 v114, 64, v112
    v_xor_b32 v115, 96, v112
    v_xor_b32 v116, 128, v112
    v_xor_b32 v117, 160, v112
    v_xor_b32 v118, 192, v112
    v_xor_b32 v119, 224, v112
    s_and_b32 s76, s72, 1
    s_lshl_b32 s76, s76, 5
    s_and_b32 s77, s69, 1
    s_mul_i32 s77, s77, 80
    s_add_u32 s76, s76, s77
    s_add_u32 s76, s76, 16384
    v_lshlrev_b32 v3, 3, v3
    v_bfe_u32 v4, v0, 2, 2
    v_add_u32 v3, v3, v4
    v_mul_u32_u24 v3, 192, v3
    v_bfe_u32 v4, v0, 4, 1
    v_lshlrev_b32 v4, 5, v4
    v_add_u32 v3, v3, v4
    v_and_b32 v4, 3, v0
    v_lshlrev_b32 v4, 3, v4
    v_add3_u32 v120, v3, v4, s76
    s_mul_i32 s76, s70, 21504
    s_add_u32 s76, s76, 81920
    s_mul_i32 s77, s70, 21504
    s_add_u32 s77, s77, 0
    v_add_u32 v26, s76, v1
    v_add_u32 v27, s77, v1
    v_and_b32 v4, 31, v0
    v_lshlrev_b32 v5, 3, v4
    v_add_u32 v5, 2432, v5
    v_add_u32 v28, s76, v5
    v_add_u32 v29, s77, v5
    v_lshrrev_b32 v2, 5, v0
    v_min_u32 v3, 21, v4
    v_mul_u32_u24 v5, 22, v2
    v_add_u32 v3, v3, v5
    v_lshlrev_b32 v3, 4, v3
    v_add_u32 v3, 1024, v3
    v_add_u32 v30, s76, v3
    v_add_u32 v31, s77, v3
    s_mul_i32 s76, s72, 20
    s_and_b32 s77, s69, 1
    s_mul_i32 s77, s77, 10
    s_add_u32 s76, s76, s77
    s_mul_i32 s77, s70, 5
    s_add_u32 s76, s76, s77
    s_mul_i32 s77, s71, 81920
    s_lshr_b32 s78, s69, 1
    s_mul_i32 s78, s78, 40960
    s_add_u32 s77, s77, s78
    s_add_u32 s77, s77, 3145728
    v_lshrrev_b32 v5, 4, v4
    v_mul_u32_u24 v5, 20480, v5
    v_and_b32 v6, 15, v0
    v_lshlrev_b32 v6, 4, v6
    v_add_u32 v5, v5, v6
    v_add_u32 v5, s77, v5
    s_add_u32 s78, s76, 0
    v_add_u32 v6, s78, v2
    v_lshrrev_b32 v7, 3, v6
    v_lshlrev_b32 v7, 10, v7
    v_bfe_u32 v8, v6, 2, 1
    v_lshlrev_b32 v8, 9, v8
    v_add_u32 v7, v7, v8
    v_and_b32 v8, 1, v6
    v_lshlrev_b32 v8, 8, v8
    v_add_u32 v7, v7, v8
    v_bfe_u32 v8, v6, 1, 1
    v_lshlrev_b32 v8, 3, v8
    v_add3_u32 v23, v7, v8, v5
    s_add_u32 s78, s76, 2
    v_add_u32 v6, s78, v2
    v_lshrrev_b32 v7, 3, v6
    v_lshlrev_b32 v7, 10, v7
    v_bfe_u32 v8, v6, 2, 1
    v_lshlrev_b32 v8, 9, v8
    v_add_u32 v7, v7, v8
    v_and_b32 v8, 1, v6
    v_lshlrev_b32 v8, 8, v8
    v_add_u32 v7, v7, v8
    v_bfe_u32 v8, v6, 1, 1
    v_lshlrev_b32 v8, 3, v8
    v_add3_u32 v24, v7, v8, v5
    s_add_u32 s78, s76, 4
    v_mov_b32 v6, s78
    v_lshrrev_b32 v7, 3, v6
    v_lshlrev_b32 v7, 10, v7
    v_bfe_u32 v8, v6, 2, 1
    v_lshlrev_b32 v8, 9, v8
    v_add_u32 v7, v7, v8
    v_and_b32 v8, 1, v6
    v_lshlrev_b32 v8, 8, v8
    v_add_u32 v7, v7, v8
    v_bfe_u32 v8, v6, 1, 1
    v_lshlrev_b32 v8, 3, v8
    v_add3_u32 v25, v7, v8, v5
    v_cmp_gt_u32 vcc, 32, v0
    v_mov_b32 v7, 0x7fffffff
    s_nop 0
    v_cndmask_b32 v25, v7, v25, vcc
    s_mov_b32 s48, s12
    s_mov_b32 s49, s13
    s_mov_b32 s50, 819200
    s_mov_b32 s51, 0x20000
    s_mov_b32 s60, s28
    s_mov_b32 s61, s29
    s_mov_b32 s62, 5242880
    s_mov_b32 s63, 0x20000
    v_mov_b32 v32, 0
    v_mov_b32 v33, 0
    v_mov_b32 v34, 0
    v_mov_b32 v35, 0
    v_mov_b32 v36, 0
    v_mov_b32 v37, 0
    v_mov_b32 v38, 0
    v_mov_b32 v39, 0
    v_mov_b32 v40, 0
    v_mov_b32 v41, 0
    v_mov_b32 v42, 0
    v_mov_b32 v43, 0
    v_mov_b32 v44, 0
    v_mov_b32 v45, 0
    v_mov_b32 v46, 0
    v_mov_b32 v47, 0
    v_mov_b32 v48, 0
    v_mov_b32 v49, 0
    v_mov_b32 v50, 0
    v_mov_b32 v51, 0
    v_mov_b32 v52, 0
    v_mov_b32 v53, 0
    v_mov_b32 v54, 0
    v_mov_b32 v55, 0
    v_mov_b32 v56, 0
    v_mov_b32 v57, 0
    v_mov_b32 v58, 0
    v_mov_b32 v59, 0
    v_mov_b32 v60, 0
    v_mov_b32 v61, 0
    v_mov_b32 v62, 0
    v_mov_b32 v63, 0
    s_mul_i32 s76, s69, 3072
    s_add_u32 s76, s76, 124928
    v_add_u32 v8, s76, v1
    s_waitcnt vmcnt(10)
    v_mov_b32 v2, 163380
    v_mov_b32 v3, 1
    s_mov_b64 exec, 1
    ds_add_u32 v2, v3
    s_mov_b64 exec, -1
    s_lshl_b32 s86, s98, 8
    s_add_u32 s86, s86, s88
    s_mul_i32 s87, s98, 163840
    s_add_u32 s87, s87, s89
    s_lshl_b32 s90, s69, 10
    s_mul_i32 s91, s69, 6144
    s_add_u32 s98, s98, 1
    s_cmp_eq_u32 s98, 5
    s_cselect_b32 s98, 0, s98
    s_add_u32 m0, s90, 40960
    s_add_u32 s84, s86, 0
    buffer_load_dwordx4 v159, s[36:39], s84 offen lds
    s_add_u32 m0, s90, 45056
    s_add_u32 s84, s86, 20480
    buffer_load_dwordx4 v159, s[36:39], s84 offen lds
    s_add_u32 m0, s90, 49152
    s_add_u32 s84, s86, 40960
    buffer_load_dwordx4 v159, s[36:39], s84 offen lds
    s_add_u32 m0, s90, 53248
    s_add_u32 s84, s86, 61440
    buffer_load_dwordx4 v159, s[36:39], s84 offen lds
    s_add_u32 m0, s91, 57344
    s_add_u32 s84, s87, 0
    buffer_load_dwordx4 v160, s[40:43], s84 offen lds
    s_add_u32 m0, s91, 58368
    s_add_u32 s84, s87, 0
    buffer_load_dwordx4 v161, s[40:43], s84 offen lds
    s_add_u32 m0, s91, 59392
    s_add_u32 s84, s87, 0
    buffer_load_dwordx4 v162, s[40:43], s84 offen lds
    s_add_u32 m0, s91, 60416
    s_add_u32 s84, s87, 20480
    buffer_load_dwordx4 v160, s[40:43], s84 offen lds
    s_add_u32 m0, s91, 61440
    s_add_u32 s84, s87, 20480
    buffer_load_dwordx4 v161, s[40:43], s84 offen lds
    s_add_u32 m0, s91, 62464
    s_add_u32 s84, s87, 20480
    buffer_load_dwordx4 v162, s[40:43], s84 offen lds
    s_waitcnt vmcnt(10)
    v_mov_b32 v2, 163360
    v_mov_b32 v3, 1
    s_mov_b64 exec, 1
    ds_add_u32 v2, v3
    s_mov_b64 exec, -1
    s_mov_b32 s97, 0
    v_mov_b32 v2, 163384
L_qkvf2:
    ds_read_b32 v3, v2
    s_add_u32 s97, s97, 1
    s_cmp_gt_u32 s97, 0x1000000
    s_cbranch_scc1 L_qkvf2_done
    s_waitcnt lgkmcnt(0)
    v_cmp_gt_u32 vcc, 4, v3
    s_cbranch_vccz L_qkvf2_done
    s_branch L_qkvf2
L_qkvf2_done:
    s_lshl_b32 s86, s98, 8
    s_add_u32 s86, s86, s88
    s_mul_i32 s87, s98, 163840
    s_add_u32 s87, s87, s89
    s_lshl_b32 s90, s69, 10
    s_mul_i32 s91, s69, 6144
    s_add_u32 s98, s98, 1
    s_cmp_eq_u32 s98, 5
    s_cselect_b32 s98, 0, s98
    s_add_u32 m0, s90, 81920
    s_add_u32 s84, s86, 0
    buffer_load_dwordx4 v159, s[36:39], s84 offen lds
    s_add_u32 m0, s90, 86016
    s_add_u32 s84, s86, 20480
    buffer_load_dwordx4 v159, s[36:39], s84 offen lds
    s_add_u32 m0, s90, 90112
    s_add_u32 s84, s86, 40960
    buffer_load_dwordx4 v159, s[36:39], s84 offen lds
    s_add_u32 m0, s90, 94208
    s_add_u32 s84, s86, 61440
    buffer_load_dwordx4 v159, s[36:39], s84 offen lds
    s_add_u32 m0, s91, 98304
    s_add_u32 s84, s87, 0
    buffer_load_dwordx4 v160, s[40:43], s84 offen lds
    s_add_u32 m0, s91, 99328
    s_add_u32 s84, s87, 0
    buffer_load_dwordx4 v161, s[40:43], s84 offen lds
    s_add_u32 m0, s91, 100352
    s_add_u32 s84, s87, 0
    buffer_load_dwordx4 v162, s[40:43], s84 offen lds
    s_add_u32 m0, s91, 101376
    s_add_u32 s84, s87, 20480
    buffer_load_dwordx4 v160, s[40:43], s84 offen lds
    s_add_u32 m0, s91, 102400
    s_add_u32 s84, s87, 20480
    buffer_load_dwordx4 v161, s[40:43], s84 offen lds
    s_add_u32 m0, s91, 103424
    s_add_u32 s84, s87, 20480
    buffer_load_dwordx4 v162, s[40:43], s84 offen lds
    s_setprio 3
    s_mov_b32 s97, 0
    v_mov_b32 v2, 163360
L_q0:
    ds_read_b32 v3, v2
    s_add_u32 s97, s97, 1
    s_cmp_gt_u32 s97, 0x1000000
    s_cbranch_scc1 L_q0_done
    s_waitcnt lgkmcnt(0)
    v_cmp_gt_u32 vcc, 4, v3
    s_cbranch_vccz L_q0_done
    s_branch L_q0
L_q0_done:
    s_mov_b32 s96, 4
    s_mov_b32 s79, 0
    v_mov_b32 v6, 163360
    v_mov_b32 v7, 1
    ds_read_b128 v[64:67], v112
    ds_read_b64_tr_b16 v[68:69], v120 offset:0
    ds_read_b64_tr_b16 v[70:71], v120 offset:768
    ds_read_b64_tr_b16 v[72:73], v120 offset:40
    ds_read_b64_tr_b16 v[74:75], v120 offset:808
    ds_read_b128 v[76:79], v113
    ds_read_b64_tr_b16 v[80:81], v120 offset:3072
    ds_read_b64_tr_b16 v[82:83], v120 offset:3840
    ds_read_b64_tr_b16 v[84:85], v120 offset:3112
    ds_read_b64_tr_b16 v[86:87], v120 offset:3880
L_qp:
    ds_read_b128 v[88:91], v114
    ds_read_b64_tr_b16 v[92:93], v120 offset:6144
    ds_read_b64_tr_b16 v[94:95], v120 offset:6912
    ds_read_b64_tr_b16 v[96:97], v120 offset:6184
    ds_read_b64_tr_b16 v[98:99], v120 offset:6952
    s_waitcnt lgkmcnt(10)
    v_mfma_f32_32x32x16_bf16 v[32:47], v[68:71], v[64:67], v[32:47]
    v_mfma_f32_32x32x16_bf16 v[48:63], v[72:75], v[64:67], v[48:63]
    ds_read_b128 v[100:103], v115
    ds_read_b64_tr_b16 v[104:105], v120 offset:9216
    ds_read_b64_tr_b16 v[106:107], v120 offset:9984
    ds_read_b64_tr_b16 v[108:109], v120 offset:9256
    ds_read_b64_tr_b16 v[110:111], v120 offset:10024
    s_waitcnt lgkmcnt(10)
    v_mfma_f32_32x32x16_bf16 v[32:47], v[80:83], v[76:79], v[32:47]
    v_mfma_f32_32x32x16_bf16 v[48:63], v[84:87], v[76:79], v[48:63]
    ds_read_b128 v[64:67], v116
    ds_read_b64_tr_b16 v[68:69], v120 offset:12288
    ds_read_b64_tr_b16 v[70:71], v120 offset:13056
    ds_read_b64_tr_b16 v[72:73], v120 offset:12328
    ds_read_b64_tr_b16 v[74:75], v120 offset:13096
    s_waitcnt lgkmcnt(10)
    v_mfma_f32_32x32x16_bf16 v[32:47], v[92:95], v[88:91], v[32:47]
    v_mfma_f32_32x32x16_bf16 v[48:63], v[96:99], v[88:91], v[48:63]
    ds_read_b128 v[76:79], v117
    ds_read_b64_tr_b16 v[80:81], v120 offset:15360
    ds_read_b64_tr_b16 v[82:83], v120 offset:16128
    ds_read_b64_tr_b16 v[84:85], v120 offset:15400
    ds_read_b64_tr_b16 v[86:87], v120 offset:16168
    s_waitcnt lgkmcnt(10)
    v_mfma_f32_32x32x16_bf16 v[32:47], v[104:107], v[100:103], v[32:47]
    v_mfma_f32_32x32x16_bf16 v[48:63], v[108:111], v[100:103], v[48:63]
    ds_read_b32 v2, v6 offset:4
    ds_read_b128 v[88:91], v118
    ds_read_b64_tr_b16 v[92:93], v120 offset:18432
    ds_read_b64_tr_b16 v[94:95], v120 offset:19200
    ds_read_b64_tr_b16 v[96:97], v120 offset:18472
    ds_read_b64_tr_b16 v[98:99], v120 offset:19240
    s_waitcnt lgkmcnt(10)
    v_mfma_f32_32x32x16_bf16 v[32:47], v[68:71], v[64:67], v[32:47]
    v_mfma_f32_32x32x16_bf16 v[48:63], v[72:75], v[64:67], v[48:63]
    ds_read_b128 v[100:103], v119
    ds_read_b64_tr_b16 v[104:105], v120 offset:21504
    ds_read_b64_tr_b16 v[106:107], v120 offset:22272
    ds_read_b64_tr_b16 v[108:109], v120 offset:21544
    ds_read_b64_tr_b16 v[110:111], v120 offset:22312
    s_add_u32 s78, s79, 40960
    s_cmp_eq_u32 s78, 122880
    s_cselect_b32 s78, 0, s78
    s_sub_u32 s77, s78, s79
    s_mov_b32 s79, s78
    v_add_u32 v112, s77, v112
    v_add_u32 v113, s77, v113
    v_add_u32 v114, s77, v114
    v_add_u32 v115, s77, v115
    v_add_u32 v116, s77, v116
    v_add_u32 v117, s77, v117
    v_add_u32 v118, s77, v118
    v_add_u32 v119, s77, v119
    v_add_u32 v120, s77, v120
    s_waitcnt lgkmcnt(10)
    v_mfma_f32_32x32x16_bf16 v[32:47], v[80:83], v[76:79], v[32:47]
    v_mfma_f32_32x32x16_bf16 v[48:63], v[84:87], v[76:79], v[48:63]
    s_cmp_eq_u32 s96, 0
    s_cbranch_scc1 L_qp_tail
    s_cmp_lt_u32 s96, 3
    s_cbranch_scc1 L_qp_noown
    s_cmp_eq_u32 s96, 4
    s_cbranch_scc1 L_qp_w10
    s_waitcnt vmcnt(0)
L_qp_w10:
    s_waitcnt vmcnt(10)
    s_mov_b64 exec, 1
    ds_add_u32 v6, v7 offset:4
    s_mov_b64 exec, -1
L_qp_noown:
    v_cmp_gt_u32 vcc, 4, v2
    s_cbranch_vccz L_qgo
    s_mov_b32 s97, 0
L_qspin:
    ds_read_b32 v2, v6 offset:4
    s_add_u32 s97, s97, 1
    s_cmp_gt_u32 s97, 0x1000000
    s_cbranch_scc1 L_qgo
    s_waitcnt lgkmcnt(0)
    v_cmp_gt_u32 vcc, 4, v2
    s_cbranch_vccnz L_qspin
L_qgo:
    ds_read_b128 v[64:67], v112
    ds_read_b64_tr_b16 v[68:69], v120 offset:0
    ds_read_b64_tr_b16 v[70:71], v120 offset:768
    ds_read_b64_tr_b16 v[72:73], v120 offset:40
    ds_read_b64_tr_b16 v[74:75], v120 offset:808
    s_waitcnt lgkmcnt(10)
    v_mfma_f32_32x32x16_bf16 v[32:47], v[92:95], v[88:91], v[32:47]
    v_mfma_f32_32x32x16_bf16 v[48:63], v[96:99], v[88:91], v[48:63]
    ds_read_b128 v[76:79], v113
    ds_read_b64_tr_b16 v[80:81], v120 offset:3072
    ds_read_b64_tr_b16 v[82:83], v120 offset:3840
    ds_read_b64_tr_b16 v[84:85], v120 offset:3112
    ds_read_b64_tr_b16 v[86:87], v120 offset:3880
    s_waitcnt lgkmcnt(10)
    v_mfma_f32_32x32x16_bf16 v[32:47], v[104:107], v[100:103], v[32:47]
    s_mov_b64 exec, 1
    ds_add_u32 v6, v7 offset:32
    s_mov_b64 exec, -1
    v_mfma_f32_32x32x16_bf16 v[48:63], v[108:111], v[100:103], v[48:63]
    v_add_u32 v6, 4, v6
    s_sub_u32 s96, s96, 1
    s_branch L_qp
L_qp_tail:
    s_waitcnt lgkmcnt(5)
    v_mfma_f32_32x32x16_bf16 v[32:47], v[92:95], v[88:91], v[32:47]
    v_mfma_f32_32x32x16_bf16 v[48:63], v[96:99], v[88:91], v[48:63]
    s_waitcnt lgkmcnt(0)
    v_mfma_f32_32x32x16_bf16 v[32:47], v[104:107], v[100:103], v[32:47]
    v_mfma_f32_32x32x16_bf16 v[48:63], v[108:111], v[100:103], v[48:63]
    v_cmp_gt_u32 vcc, 32, v0
    s_nop 9
    v_cvt_pk_bf16_f32 v10, v32, v33
    v_cvt_pk_bf16_f32 v11, v34, v35
    v_cvt_pk_bf16_f32 v12, v36, v37
    v_cvt_pk_bf16_f32 v13, v38, v39
    v_cvt_pk_bf16_f32 v14, v40, v41
    v_cndmask_b32 v14, 0, v14, vcc
    v_cvt_pk_bf16_f32 v15, v42, v43
    v_cndmask_b32 v15, 0, v15, vcc
    ds_write_b128 v8, v[10:13]
    v_cvt_pk_bf16_f32 v16, v48, v49
    v_cvt_pk_bf16_f32 v17, v50, v51
    v_cvt_pk_bf16_f32 v18, v52, v53
    v_cvt_pk_bf16_f32 v19, v54, v55
    v_cvt_pk_bf16_f32 v20, v56, v57
    v_cndmask_b32 v20, 0, v20, vcc
    v_cvt_pk_bf16_f32 v21, v58, v59
    v_cndmask_b32 v21, 0, v21, vcc
    ds_write_b128 v8, v[14:17] offset:1024
    ds_write_b128 v8, v[18:21] offset:2048
    s_waitcnt lgkmcnt(0)
    v_mov_b32 v2, 163416
    v_mov_b32 v3, 1
    s_mov_b64 exec, 1
    ds_add_u32 v2, v3
    s_mov_b64 exec, -1
    s_mov_b32 s97, 0
    v_mov_b32 v2, 163416
L_goQ:
    ds_read_b32 v3, v2
    s_add_u32 s97, s97, 1
    s_cmp_gt_u32 s97, 0x1000000
    s_cbranch_scc1 L_goQ_done
    s_waitcnt lgkmcnt(0)
    v_cmp_gt_u32 vcc, 8, v3
    s_cbranch_vccz L_goQ_done
    s_branch L_goQ
L_goQ_done:
L_A1:
    v_mov_b32 v2, 163072
    ds_read_b128 v[36:39], v2
    ds_read_b128 v[112:115], v26 offset:0
    ds_read_b64 v[116:117], v28 offset:0
    ds_read_b128 v[120:123], v30 offset:0
    ds_read_b128 v[124:127], v30 offset:704
    s_setprio 1
    v_mov_b32 v6, 163408
    v_mov_b32 v7, 1
    s_waitcnt lgkmcnt(4)
    s_mov_b64 exec, 1
    ds_add_u32 v6, v7
    s_mov_b64 exec, -1
    v_dot2_f32_bf16 v4, v10, v10, 0
    v_dot2_f32_bf16 v4, v11, v11, v4
    v_dot2_f32_bf16 v4, v12, v12, v4
    v_dot2_f32_bf16 v4, v13, v13, v4
    v_dot2_f32_bf16 v4, v14, v14, v4
    v_dot2_f32_bf16 v4, v15, v15, v4
    v_dot2_f32_bf16 v5, v16, v16, 0
    v_dot2_f32_bf16 v5, v17, v17, v5
    v_dot2_f32_bf16 v5, v18, v18, v5
    v_dot2_f32_bf16 v5, v19, v19, v5
    v_dot2_f32_bf16 v5, v20, v20, v5
    v_dot2_f32_bf16 v5, v21, v21, v5
    s_nop 2
    v_max_u32 v4, v4, v5
    v_readfirstlane_b32 s101, v37
    v_readfirstlane_b32 s3, v38
    v_cmp_nle_f32 vcc, v4, v36
    s_cbranch_vccnz L_fallback
    v_mov_b32 v8, 163424
    v_mov_b32 v9, 1
    s_waitcnt lgkmcnt(0)
    v_mfma_f32_32x32x16_bf16 v[32:47], v[112:115], v[10:13], 0
    v_mfma_f32_32x32x8bf16_1k v[32:47], v[116:117], v[14:15], v[32:47]
    s_nop 11
    v_mfma_f32_32x32x16_bf16 v[48:63], v[112:115], v[16:19], 0
    ds_read_b128 v[112:115], v26 offset:2688
    v_exp_f32 v32, v32
    v_exp_f32 v33, v33
    v_exp_f32 v34, v34
    v_exp_f32 v35, v35
    v_mfma_f32_32x32x8bf16_1k v[48:63], v[116:117], v[20:21], v[48:63]
    ds_read_b64 v[116:117], v28 offset:2688
    v_exp_f32 v36, v36
    v_exp_f32 v37, v37
    v_cvt_pk_bf16_f32 v64, v32, v33
    v_exp_f32 v38, v38
    v_exp_f32 v39, v39
    v_cvt_pk_bf16_f32 v65, v34, v35
    v_exp_f32 v40, v40
    v_exp_f32 v41, v41
    v_cvt_pk_bf16_f32 v66, v36, v37
    v_exp_f32 v42, v42
    v_exp_f32 v43, v43
    v_cvt_pk_bf16_f32 v67, v38, v39
    v_exp_f32 v44, v44
    v_exp_f32 v45, v45
    v_cvt_pk_bf16_f32 v68, v40, v41
    v_exp_f32 v46, v46
    v_exp_f32 v47, v47
    v_cvt_pk_bf16_f32 v69, v42, v43
    v_cvt_pk_bf16_f32 v70, v44, v45
    v_cvt_pk_bf16_f32 v71, v46, v47
    s_waitcnt lgkmcnt(0)
    v_mfma_f32_32x32x16_bf16 v[32:47], v[112:115], v[10:13], 0
    ds_read_b128 v[128:131], v30 offset:2688
    v_exp_f32 v48, v48
    v_exp_f32 v49, v49
    v_exp_f32 v50, v50
    v_exp_f32 v51, v51
    v_mfma_f32_32x32x8bf16_1k v[32:47], v[116:117], v[14:15], v[32:47]
    ds_read_b128 v[132:135], v30 offset:3392
    v_exp_f32 v52, v52
    v_exp_f32 v53, v53
    v_cvt_pk_bf16_f32 v72, v48, v49
    v_exp_f32 v54, v54
    v_exp_f32 v55, v55
    v_cvt_pk_bf16_f32 v73, v50, v51
    v_mfma_f32_32x32x16_bf16 v[80:95], v[120:123], v[64:67], 0
    v_exp_f32 v56, v56
    v_exp_f32 v57, v57
    v_cvt_pk_bf16_f32 v74, v52, v53
    v_exp_f32 v58, v58
    v_exp_f32 v59, v59
    v_cvt_pk_bf16_f32 v75, v54, v55
    v_mfma_f32_32x32x16_bf16 v[80:95], v[124:127], v[68:71], v[80:95]
    v_exp_f32 v60, v60
    v_exp_f32 v61, v61
    v_cvt_pk_bf16_f32 v76, v56, v57
    v_exp_f32 v62, v62
    v_exp_f32 v63, v63
    v_cvt_pk_bf16_f32 v77, v58, v59
    v_cvt_pk_bf16_f32 v78, v60, v61
    v_cvt_pk_bf16_f32 v79, v62, v63
    v_mfma_f32_32x32x16_bf16 v[48:63], v[112:115], v[16:19], 0
    ds_read_b128 v[112:115], v26 offset:5376
    v_exp_f32 v32, v32
    v_exp_f32 v33, v33
    v_exp_f32 v34, v34
    v_exp_f32 v35, v35
    v_mfma_f32_32x32x8bf16_1k v[48:63], v[116:117], v[20:21], v[48:63]
    ds_read_b64 v[116:117], v28 offset:5376
    v_exp_f32 v36, v36
    v_exp_f32 v37, v37
    v_cvt_pk_bf16_f32 v64, v32, v33
    v_exp_f32 v38, v38
    v_exp_f32 v39, v39
    v_cvt_pk_bf16_f32 v65, v34, v35
    v_mfma_f32_32x32x16_bf16 v[96:111], v[120:123], v[72:75], 0
    v_exp_f32 v40, v40
    v_exp_f32 v41, v41
    v_cvt_pk_bf16_f32 v66, v36, v37
    v_exp_f32 v42, v42
    v_exp_f32 v43, v43
    v_cvt_pk_bf16_f32 v67, v38, v39
    v_mfma_f32_32x32x16_bf16 v[96:111], v[124:127], v[76:79], v[96:111]
    v_exp_f32 v44, v44
    v_exp_f32 v45, v45
    v_cvt_pk_bf16_f32 v68, v40, v41
    v_exp_f32 v46, v46
    v_exp_f32 v47, v47
    v_cvt_pk_bf16_f32 v69, v42, v43
    v_cvt_pk_bf16_f32 v70, v44, v45
    v_cvt_pk_bf16_f32 v71, v46, v47
    s_waitcnt lgkmcnt(0)
    v_mfma_f32_32x32x16_bf16 v[32:47], v[112:115], v[10:13], 0
    ds_read_b128 v[120:123], v30 offset:5376
    v_exp_f32 v48, v48
    v_exp_f32 v49, v49
    v_exp_f32 v50, v50
    v_exp_f32 v51, v51
    v_mfma_f32_32x32x8bf16_1k v[32:47], v[116:117], v[14:15], v[32:47]
    ds_read_b128 v[124:127], v30 offset:6080
    v_exp_f32 v52, v52
    v_exp_f32 v53, v53
    v_cvt_pk_bf16_f32 v72, v48, v49
    v_exp_f32 v54, v54
    v_exp_f32 v55, v55
    v_cvt_pk_bf16_f32 v73, v50, v51
    v_mfma_f32_32x32x16_bf16 v[80:95], v[128:131], v[64:67], v[80:95]
    v_exp_f32 v56, v56
    v_exp_f32 v57, v57
    v_cvt_pk_bf16_f32 v74, v52, v53
    v_exp_f32 v58, v58
    v_exp_f32 v59, v59
    v_cvt_pk_bf16_f32 v75, v54, v55
    v_mfma_f32_32x32x16_bf16 v[80:95], v[132:135], v[68:71], v[80:95]
    v_exp_f32 v60, v60
    v_exp_f32 v61, v61
    v_cvt_pk_bf16_f32 v76, v56, v57
    v_exp_f32 v62, v62
    v_exp_f32 v63, v63
    v_cvt_pk_bf16_f32 v77, v58, v59
    v_cvt_pk_bf16_f32 v78, v60, v61
    v_cvt_pk_bf16_f32 v79, v62, v63
    v_mfma_f32_32x32x16_bf16 v[48:63], v[112:115], v[16:19], 0
    ds_read_b128 v[112:115], v26 offset:8064
    v_exp_f32 v32, v32
    v_exp_f32 v33, v33
    v_exp_f32 v34, v34
    v_exp_f32 v35, v35
    v_mfma_f32_32x32x8bf16_1k v[48:63], v[116:117], v[20:21], v[48:63]
    ds_read_b64 v[116:117], v28 offset:8064
    v_exp_f32 v36, v36
    v_exp_f32 v37, v37
    v_cvt_pk_bf16_f32 v64, v32, v33
    v_exp_f32 v38, v38
    v_exp_f32 v39, v39
    v_cvt_pk_bf16_f32 v65, v34, v35
    v_mfma_f32_32x32x16_bf16 v[96:111], v[128:131], v[72:75], v[96:111]
    v_exp_f32 v40, v40
    v_exp_f32 v41, v41
    v_cvt_pk_bf16_f32 v66, v36, v37
    v_exp_f32 v42, v42
    v_exp_f32 v43, v43
    v_cvt_pk_bf16_f32 v67, v38, v39
    v_mfma_f32_32x32x16_bf16 v[96:111], v[132:135], v[76:79], v[96:111]
    v_exp_f32 v44, v44
    v_exp_f32 v45, v45
    v_cvt_pk_bf16_f32 v68, v40, v41
    v_exp_f32 v46, v46
    v_exp_f32 v47, v47
    v_cvt_pk_bf16_f32 v69, v42, v43
    v_cvt_pk_bf16_f32 v70, v44, v45
    v_cvt_pk_bf16_f32 v71, v46, v47
    s_waitcnt lgkmcnt(0)
    v_mfma_f32_32x32x16_bf16 v[32:47], v[112:115], v[10:13], 0
    ds_read_b128 v[128:131], v30 offset:8064
    v_exp_f32 v48, v48
    v_exp_f32 v49, v49
    v_exp_f32 v50, v50
    v_exp_f32 v51, v51
    v_mfma_f32_32x32x8bf16_1k v[32:47], v[116:117], v[14:15], v[32:47]
    ds_read_b128 v[132:135], v30 offset:8768
    v_exp_f32 v52, v52
    v_exp_f32 v53, v53
    v_cvt_pk_bf16_f32 v72, v48, v49
    v_exp_f32 v54, v54
    v_exp_f32 v55, v55
    v_cvt_pk_bf16_f32 v73, v50, v51
    v_mfma_f32_32x32x16_bf16 v[80:95], v[120:123], v[64:67], v[80:95]
    v_exp_f32 v56, v56
    v_exp_f32 v57, v57
    v_cvt_pk_bf16_f32 v74, v52, v53
    v_exp_f32 v58, v58
    v_exp_f32 v59, v59
    v_cvt_pk_bf16_f32 v75, v54, v55
    v_mfma_f32_32x32x16_bf16 v[80:95], v[124:127], v[68:71], v[80:95]
    v_exp_f32 v60, v60
    v_exp_f32 v61, v61
    v_cvt_pk_bf16_f32 v76, v56, v57
    v_exp_f32 v62, v62
    v_exp_f32 v63, v63
    v_cvt_pk_bf16_f32 v77, v58, v59
    v_cvt_pk_bf16_f32 v78, v60, v61
    v_cvt_pk_bf16_f32 v79, v62, v63
    v_mfma_f32_32x32x16_bf16 v[48:63], v[112:115], v[16:19], 0
    ds_read_b128 v[112:115], v26 offset:10752
    v_exp_f32 v32, v32
    v_exp_f32 v33, v33
    v_exp_f32 v34, v34
    v_exp_f32 v35, v35
    v_mfma_f32_32x32x8bf16_1k v[48:63], v[116:117], v[20:21], v[48:63]
    ds_read_b64 v[116:117], v28 offset:10752
    v_exp_f32 v36, v36
    v_exp_f32 v37, v37
    v_cvt_pk_bf16_f32 v64, v32, v33
    v_exp_f32 v38, v38
    v_exp_f32 v39, v39
    v_cvt_pk_bf16_f32 v65, v34, v35
    v_mfma_f32_32x32x16_bf16 v[96:111], v[120:123], v[72:75], v[96:111]
    v_exp_f32 v40, v40
    v_exp_f32 v41, v41
    v_cvt_pk_bf16_f32 v66, v36, v37
    v_exp_f32 v42, v42
    v_exp_f32 v43, v43
    v_cvt_pk_bf16_f32 v67, v38, v39
    v_mfma_f32_32x32x16_bf16 v[96:111], v[124:127], v[76:79], v[96:111]
    v_exp_f32 v44, v44
    v_exp_f32 v45, v45
    v_cvt_pk_bf16_f32 v68, v40, v41
    v_exp_f32 v46, v46
    v_exp_f32 v47, v47
    v_cvt_pk_bf16_f32 v69, v42, v43
    v_cvt_pk_bf16_f32 v70, v44, v45
    v_cvt_pk_bf16_f32 v71, v46, v47
    s_waitcnt lgkmcnt(0)
    v_mfma_f32_32x32x16_bf16 v[32:47], v[112:115], v[10:13], 0
    ds_read_b128 v[120:123], v30 offset:10752
    v_exp_f32 v48, v48
    v_exp_f32 v49, v49
    v_exp_f32 v50, v50
    v_exp_f32 v51, v51
    v_mfma_f32_32x32x8bf16_1k v[32:47], v[116:117], v[14:15], v[32:47]
    ds_read_b128 v[124:127], v30 offset:11456
    v_exp_f32 v52, v52
    v_exp_f32 v53, v53
    v_cvt_pk_bf16_f32 v72, v48, v49
    v_exp_f32 v54, v54
    v_exp_f32 v55, v55
    v_cvt_pk_bf16_f32 v73, v50, v51
    v_mfma_f32_32x32x16_bf16 v[80:95], v[128:131], v[64:67], v[80:95]
    v_exp_f32 v56, v56
    v_exp_f32 v57, v57
    v_cvt_pk_bf16_f32 v74, v52, v53
    v_exp_f32 v58, v58
    v_exp_f32 v59, v59
    v_cvt_pk_bf16_f32 v75, v54, v55
    v_mfma_f32_32x32x16_bf16 v[80:95], v[132:135], v[68:71], v[80:95]
    v_exp_f32 v60, v60
    v_exp_f32 v61, v61
    v_cvt_pk_bf16_f32 v76, v56, v57
    v_exp_f32 v62, v62
    v_exp_f32 v63, v63
    v_cvt_pk_bf16_f32 v77, v58, v59
    v_cvt_pk_bf16_f32 v78, v60, v61
    v_cvt_pk_bf16_f32 v79, v62, v63
    v_mfma_f32_32x32x16_bf16 v[48:63], v[112:115], v[16:19], 0
    ds_read_b128 v[112:115], v26 offset:13440
    v_exp_f32 v32, v32
    v_exp_f32 v33, v33
    v_exp_f32 v34, v34
    v_exp_f32 v35, v35
    v_mfma_f32_32x32x8bf16_1k v[48:63], v[116:117], v[20:21], v[48:63]
    ds_read_b64 v[116:117], v28 offset:13440
    v_exp_f32 v36, v36
    v_exp_f32 v37, v37
    v_cvt_pk_bf16_f32 v64, v32, v33
    v_exp_f32 v38, v38
    v_exp_f32 v39, v39
    v_cvt_pk_bf16_f32 v65, v34, v35
    v_mfma_f32_32x32x16_bf16 v[96:111], v[128:131], v[72:75], v[96:111]
    v_exp_f32 v40, v40
    v_exp_f32 v41, v41
    v_cvt_pk_bf16_f32 v66, v36, v37
    v_exp_f32 v42, v42
    v_exp_f32 v43, v43
    v_cvt_pk_bf16_f32 v67, v38, v39
    v_mfma_f32_32x32x16_bf16 v[96:111], v[132:135], v[76:79], v[96:111]
    v_exp_f32 v44, v44
    v_exp_f32 v45, v45
    v_cvt_pk_bf16_f32 v68, v40, v41
    v_exp_f32 v46, v46
    v_exp_f32 v47, v47
    v_cvt_pk_bf16_f32 v69, v42, v43
    v_cvt_pk_bf16_f32 v70, v44, v45
    v_cvt_pk_bf16_f32 v71, v46, v47
    s_waitcnt lgkmcnt(0)
    v_mfma_f32_32x32x16_bf16 v[32:47], v[112:115], v[10:13], 0
    ds_read_b128 v[128:131], v30 offset:13440
    v_exp_f32 v48, v48
    v_exp_f32 v49, v49
    v_exp_f32 v50, v50
    v_exp_f32 v51, v51
    v_mfma_f32_32x32x8bf16_1k v[32:47], v[116:117], v[14:15], v[32:47]
    ds_read_b128 v[132:135], v30 offset:14144
    v_exp_f32 v52, v52
    v_exp_f32 v53, v53
    v_cvt_pk_bf16_f32 v72, v48, v49
    v_exp_f32 v54, v54
    v_exp_f32 v55, v55
    v_cvt_pk_bf16_f32 v73, v50, v51
    v_mfma_f32_32x32x16_bf16 v[80:95], v[120:123], v[64:67], v[80:95]
    v_exp_f32 v56, v56
    v_exp_f32 v57, v57
    v_cvt_pk_bf16_f32 v74, v52, v53
    v_exp_f32 v58, v58
    v_exp_f32 v59, v59
    v_cvt_pk_bf16_f32 v75, v54, v55
    v_mfma_f32_32x32x16_bf16 v[80:95], v[124:127], v[68:71], v[80:95]
    v_exp_f32 v60, v60
    v_exp_f32 v61, v61
    v_cvt_pk_bf16_f32 v76, v56, v57
    v_exp_f32 v62, v62
    v_exp_f32 v63, v63
    v_cvt_pk_bf16_f32 v77, v58, v59
    v_cvt_pk_bf16_f32 v78, v60, v61
    v_cvt_pk_bf16_f32 v79, v62, v63
    v_mfma_f32_32x32x16_bf16 v[48:63], v[112:115], v[16:19], 0
    ds_read_b128 v[112:115], v26 offset:16128
    v_exp_f32 v32, v32
    v_exp_f32 v33, v33
    v_exp_f32 v34, v34
    v_exp_f32 v35, v35
    v_mfma_f32_32x32x8bf16_1k v[48:63], v[116:117], v[20:21], v[48:63]
    ds_read_b64 v[116:117], v28 offset:16128
    v_exp_f32 v36, v36
    v_exp_f32 v37, v37
    v_cvt_pk_bf16_f32 v64, v32, v33
    v_exp_f32 v38, v38
    v_exp_f32 v39, v39
    v_cvt_pk_bf16_f32 v65, v34, v35
    v_mfma_f32_32x32x16_bf16 v[96:111], v[120:123], v[72:75], v[96:111]
    v_exp_f32 v40, v40
    v_exp_f32 v41, v41
    v_cvt_pk_bf16_f32 v66, v36, v37
    v_exp_f32 v42, v42
    v_exp_f32 v43, v43
    v_cvt_pk_bf16_f32 v67, v38, v39
    v_mfma_f32_32x32x16_bf16 v[96:111], v[124:127], v[76:79], v[96:111]
    v_exp_f32 v44, v44
    v_exp_f32 v45, v45
    v_cvt_pk_bf16_f32 v68, v40, v41
    v_exp_f32 v46, v46
    v_exp_f32 v47, v47
    v_cvt_pk_bf16_f32 v69, v42, v43
    v_cvt_pk_bf16_f32 v70, v44, v45
    v_cvt_pk_bf16_f32 v71, v46, v47
    s_waitcnt lgkmcnt(0)
    v_mfma_f32_32x32x16_bf16 v[32:47], v[112:115], v[10:13], 0
    ds_read_b128 v[120:123], v30 offset:16128
    v_exp_f32 v48, v48
    v_exp_f32 v49, v49
    v_exp_f32 v50, v50
    v_exp_f32 v51, v51
    v_mfma_f32_32x32x8bf16_1k v[32:47], v[116:117], v[14:15], v[32:47]
    ds_read_b128 v[124:127], v30 offset:16832
    v_exp_f32 v52, v52
    v_exp_f32 v53, v53
    v_cvt_pk_bf16_f32 v72, v48, v49
    v_exp_f32 v54, v54
    v_exp_f32 v55, v55
    v_cvt_pk_bf16_f32 v73, v50, v51
    v_mfma_f32_32x32x16_bf16 v[80:95], v[128:131], v[64:67], v[80:95]
    v_exp_f32 v56, v56
    v_exp_f32 v57, v57
    v_cvt_pk_bf16_f32 v74, v52, v53
    v_exp_f32 v58, v58
    v_exp_f32 v59, v59
    v_cvt_pk_bf16_f32 v75, v54, v55
    v_mfma_f32_32x32x16_bf16 v[80:95], v[132:135], v[68:71], v[80:95]
    v_exp_f32 v60, v60
    v_exp_f32 v61, v61
    v_cvt_pk_bf16_f32 v76, v56, v57
    v_exp_f32 v62, v62
    v_exp_f32 v63, v63
    v_cvt_pk_bf16_f32 v77, v58, v59
    v_cvt_pk_bf16_f32 v78, v60, v61
    v_cvt_pk_bf16_f32 v79, v62, v63
    v_mfma_f32_32x32x16_bf16 v[48:63], v[112:115], v[16:19], 0
    ds_read_b128 v[112:115], v26 offset:18816
    v_exp_f32 v32, v32
    v_exp_f32 v33, v33
    v_exp_f32 v34, v34
    v_exp_f32 v35, v35
    v_mfma_f32_32x32x8bf16_1k v[48:63], v[116:117], v[20:21], v[48:63]
    ds_read_b64 v[116:117], v28 offset:18816
    v_exp_f32 v36, v36
    v_exp_f32 v37, v37
    v_cvt_pk_bf16_f32 v64, v32, v33
    v_exp_f32 v38, v38
    v_exp_f32 v39, v39
    v_cvt_pk_bf16_f32 v65, v34, v35
    v_mfma_f32_32x32x16_bf16 v[96:111], v[128:131], v[72:75], v[96:111]
    v_exp_f32 v40, v40
    v_exp_f32 v41, v41
    v_cvt_pk_bf16_f32 v66, v36, v37
    v_exp_f32 v42, v42
    v_exp_f32 v43, v43
    v_cvt_pk_bf16_f32 v67, v38, v39
    v_mfma_f32_32x32x16_bf16 v[96:111], v[132:135], v[76:79], v[96:111]
    v_exp_f32 v44, v44
    v_exp_f32 v45, v45
    v_cvt_pk_bf16_f32 v68, v40, v41
    v_exp_f32 v46, v46
    v_exp_f32 v47, v47
    v_cvt_pk_bf16_f32 v69, v42, v43
    v_cvt_pk_bf16_f32 v70, v44, v45
    v_cvt_pk_bf16_f32 v71, v46, v47
    s_waitcnt lgkmcnt(0)
    v_mfma_f32_32x32x16_bf16 v[32:47], v[112:115], v[10:13], 0
    ds_read_b128 v[128:131], v30 offset:18816
    v_exp_f32 v48, v48
    v_exp_f32 v49, v49
    v_exp_f32 v50, v50
    v_exp_f32 v51, v51
    v_mfma_f32_32x32x8bf16_1k v[32:47], v[116:117], v[14:15], v[32:47]
    ds_read_b128 v[132:135], v30 offset:19520
    v_exp_f32 v52, v52
    v_exp_f32 v53, v53
    v_cvt_pk_bf16_f32 v72, v48, v49
    v_exp_f32 v54, v54
    v_exp_f32 v55, v55
    v_cvt_pk_bf16_f32 v73, v50, v51
    v_mfma_f32_32x32x16_bf16 v[80:95], v[120:123], v[64:67], v[80:95]
    ds_read_b32 v2, v8 offset:4
    v_exp_f32 v56, v56
    v_exp_f32 v57, v57
    v_cvt_pk_bf16_f32 v74, v52, v53
    v_exp_f32 v58, v58
    v_exp_f32 v59, v59
    v_cvt_pk_bf16_f32 v75, v54, v55
    v_mfma_f32_32x32x16_bf16 v[80:95], v[124:127], v[68:71], v[80:95]
    v_exp_f32 v60, v60
    v_exp_f32 v61, v61
    v_cvt_pk_bf16_f32 v76, v56, v57
    v_exp_f32 v62, v62
    v_exp_f32 v63, v63
    v_cvt_pk_bf16_f32 v77, v58, v59
    v_cvt_pk_bf16_f32 v78, v60, v61
    v_cvt_pk_bf16_f32 v79, v62, v63
    v_mfma_f32_32x32x16_bf16 v[48:63], v[112:115], v[16:19], 0
    s_waitcnt lgkmcnt(0)
    s_mov_b64 exec, 1
    ds_add_u32 v8, v9 offset:16
    s_mov_b64 exec, -1
    v_cmp_eq_u32 vcc, 4, v2
    s_cbranch_vccz L_ring0
L_ring0_ok:
    ds_read_b128 v[112:115], v27 offset:0
    v_exp_f32 v32, v32
    v_exp_f32 v33, v33
    v_exp_f32 v34, v34
    v_exp_f32 v35, v35
    v_mfma_f32_32x32x8bf16_1k v[48:63], v[116:117], v[20:21], v[48:63]
    ds_read_b64 v[116:117], v29 offset:0
    v_exp_f32 v36, v36
    v_exp_f32 v37, v37
    v_cvt_pk_bf16_f32 v64, v32, v33
    v_exp_f32 v38, v38
    v_exp_f32 v39, v39
    v_cvt_pk_bf16_f32 v65, v34, v35
    v_mfma_f32_32x32x16_bf16 v[96:111], v[120:123], v[72:75], v[96:111]
    v_exp_f32 v40, v40
    v_exp_f32 v41, v41
    v_cvt_pk_bf16_f32 v66, v36, v37
    v_exp_f32 v42, v42
    v_exp_f32 v43, v43
    v_cvt_pk_bf16_f32 v67, v38, v39
    v_mfma_f32_32x32x16_bf16 v[96:111], v[124:127], v[76:79], v[96:111]
    v_exp_f32 v44, v44
    v_exp_f32 v45, v45
    v_cvt_pk_bf16_f32 v68, v40, v41
    v_exp_f32 v46, v46
    v_exp_f32 v47, v47
    v_cvt_pk_bf16_f32 v69, v42, v43
    v_cvt_pk_bf16_f32 v70, v44, v45
    v_cvt_pk_bf16_f32 v71, v46, v47
    s_waitcnt lgkmcnt(0)
    v_mfma_f32_32x32x16_bf16 v[32:47], v[112:115], v[10:13], 0
    ds_read_b128 v[120:123], v31 offset:0
    v_exp_f32 v48, v48
    v_exp_f32 v49, v49
    v_exp_f32 v50, v50
    v_exp_f32 v51, v51
    v_mfma_f32_32x32x8bf16_1k v[32:47], v[116:117], v[14:15], v[32:47]
    ds_read_b128 v[124:127], v31 offset:704
    v_exp_f32 v52, v52
    v_exp_f32 v53, v53
    v_cvt_pk_bf16_f32 v72, v48, v49
    v_exp_f32 v54, v54
    v_exp_f32 v55, v55
    v_cvt_pk_bf16_f32 v73, v50, v51
    v_mfma_f32_32x32x16_bf16 v[80:95], v[128:131], v[64:67], v[80:95]
    v_exp_f32 v56, v56
    v_exp_f32 v57, v57
    v_cvt_pk_bf16_f32 v74, v52, v53
    v_exp_f32 v58, v58
    v_exp_f32 v59, v59
    v_cvt_pk_bf16_f32 v75, v54, v55
    v_mfma_f32_32x32x16_bf16 v[80:95], v[132:135], v[68:71], v[80:95]
    v_exp_f32 v60, v60
    v_exp_f32 v61, v61
    v_cvt_pk_bf16_f32 v76, v56, v57
    v_exp_f32 v62, v62
    v_exp_f32 v63, v63
    v_cvt_pk_bf16_f32 v77, v58, v59
    v_cvt_pk_bf16_f32 v78, v60, v61
    v_cvt_pk_bf16_f32 v79, v62, v63
    v_mfma_f32_32x32x16_bf16 v[48:63], v[112:115], v[16:19], 0
    ds_read_b128 v[112:115], v27 offset:2688
    v_exp_f32 v32, v32
    v_exp_f32 v33, v33
    v_exp_f32 v34, v34
    v_exp_f32 v35, v35
    v_mfma_f32_32x32x8bf16_1k v[48:63], v[116:117], v[20:21], v[48:63]
    ds_read_b64 v[116:117], v29 offset:2688
    v_exp_f32 v36, v36
    v_exp_f32 v37, v37
    v_cvt_pk_bf16_f32 v64, v32, v33
    v_exp_f32 v38, v38
    v_exp_f32 v39, v39
    v_cvt_pk_bf16_f32 v65, v34, v35
    v_mfma_f32_32x32x16_bf16 v[96:111], v[128:131], v[72:75], v[96:111]
    v_exp_f32 v40, v40
    v_exp_f32 v41, v41
    v_cvt_pk_bf16_f32 v66, v36, v37
    v_exp_f32 v42, v42
    v_exp_f32 v43, v43
    v_cvt_pk_bf16_f32 v67, v38, v39
    v_mfma_f32_32x32x16_bf16 v[96:111], v[132:135], v[76:79], v[96:111]
    v_exp_f32 v44, v44
    v_exp_f32 v45, v45
    v_cvt_pk_bf16_f32 v68, v40, v41
    v_exp_f32 v46, v46
    v_exp_f32 v47, v47
    v_cvt_pk_bf16_f32 v69, v42, v43
    v_cvt_pk_bf16_f32 v70, v44, v45
    v_cvt_pk_bf16_f32 v71, v46, v47
    s_waitcnt lgkmcnt(0)
    v_mfma_f32_32x32x16_bf16 v[32:47], v[112:115], v[10:13], 0
    ds_read_b128 v[128:131], v31 offset:2688
    v_exp_f32 v48, v48
    v_exp_f32 v49, v49
    v_exp_f32 v50, v50
    v_exp_f32 v51, v51
    v_mfma_f32_32x32x8bf16_1k v[32:47], v[116:117], v[14:15], v[32:47]
    ds_read_b128 v[132:135], v31 offset:3392
    v_exp_f32 v52, v52
    v_exp_f32 v53, v53
    v_cvt_pk_bf16_f32 v72, v48, v49
    v_exp_f32 v54, v54
    v_exp_f32 v55, v55
    v_cvt_pk_bf16_f32 v73, v50, v51
    v_mfma_f32_32x32x16_bf16 v[80:95], v[120:123], v[64:67], v[80:95]
    v_exp_f32 v56, v56
    v_exp_f32 v57, v57
    v_cvt_pk_bf16_f32 v74, v52, v53
    v_exp_f32 v58, v58
    v_exp_f32 v59, v59
    v_cvt_pk_bf16_f32 v75, v54, v55
    v_mfma_f32_32x32x16_bf16 v[80:95], v[124:127], v[68:71], v[80:95]
    v_exp_f32 v60, v60
    v_exp_f32 v61, v61
    v_cvt_pk_bf16_f32 v76, v56, v57
    v_exp_f32 v62, v62
    v_exp_f32 v63, v63
    v_cvt_pk_bf16_f32 v77, v58, v59
    v_cvt_pk_bf16_f32 v78, v60, v61
    v_cvt_pk_bf16_f32 v79, v62, v63
    v_mfma_f32_32x32x16_bf16 v[48:63], v[112:115], v[16:19], 0
    ds_read_b128 v[112:115], v27 offset:5376
    v_exp_f32 v32, v32
    v_exp_f32 v33, v33
    v_exp_f32 v34, v34
    v_exp_f32 v35, v35
    v_mfma_f32_32x32x8bf16_1k v[48:63], v[116:117], v[20:21], v[48:63]
    ds_read_b64 v[116:117], v29 offset:5376
    v_exp_f32 v36, v36
    v_exp_f32 v37, v37
    v_cvt_pk_bf16_f32 v64, v32, v33
    v_exp_f32 v38, v38
    v_exp_f32 v39, v39
    v_cvt_pk_bf16_f32 v65, v34, v35
    v_mfma_f32_32x32x16_bf16 v[96:111], v[120:123], v[72:75], v[96:111]
    v_exp_f32 v40, v40
    v_exp_f32 v41, v41
    v_cvt_pk_bf16_f32 v66, v36, v37
    v_exp_f32 v42, v42
    v_exp_f32 v43, v43
    v_cvt_pk_bf16_f32 v67, v38, v39
    v_mfma_f32_32x32x16_bf16 v[96:111], v[124:127], v[76:79], v[96:111]
    v_exp_f32 v44, v44
    v_exp_f32 v45, v45
    v_cvt_pk_bf16_f32 v68, v40, v41
    v_exp_f32 v46, v46
    v_exp_f32 v47, v47
    v_cvt_pk_bf16_f32 v69, v42, v43
    v_cvt_pk_bf16_f32 v70, v44, v45
    v_cvt_pk_bf16_f32 v71, v46, v47
    s_waitcnt lgkmcnt(0)
    v_mfma_f32_32x32x16_bf16 v[32:47], v[112:115], v[10:13], 0
    ds_read_b128 v[120:123], v31 offset:5376
    v_exp_f32 v48, v48
    v_exp_f32 v49, v49
    v_exp_f32 v50, v50
    v_exp_f32 v51, v51
    v_mfma_f32_32x32x8bf16_1k v[32:47], v[116:117], v[14:15], v[32:47]
    ds_read_b128 v[124:127], v31 offset:6080
    v_exp_f32 v52, v52
    v_exp_f32 v53, v53
    v_cvt_pk_bf16_f32 v72, v48, v49
    v_exp_f32 v54, v54
    v_exp_f32 v55, v55
    v_cvt_pk_bf16_f32 v73, v50, v51
    v_mfma_f32_32x32x16_bf16 v[80:95], v[128:131], v[64:67], v[80:95]
    v_exp_f32 v56, v56
    v_exp_f32 v57, v57
    v_cvt_pk_bf16_f32 v74, v52, v53
    v_exp_f32 v58, v58
    v_exp_f32 v59, v59
    v_cvt_pk_bf16_f32 v75, v54, v55
    v_mfma_f32_32x32x16_bf16 v[80:95], v[132:135], v[68:71], v[80:95]
    v_exp_f32 v60, v60
    v_exp_f32 v61, v61
    v_cvt_pk_bf16_f32 v76, v56, v57
    v_exp_f32 v62, v62
    v_exp_f32 v63, v63
    v_cvt_pk_bf16_f32 v77, v58, v59
    v_cvt_pk_bf16_f32 v78, v60, v61
    v_cvt_pk_bf16_f32 v79, v62, v63
    v_mfma_f32_32x32x16_bf16 v[48:63], v[112:115], v[16:19], 0
    ds_read_b128 v[112:115], v27 offset:8064
    v_exp_f32 v32, v32
    v_exp_f32 v33, v33
    v_exp_f32 v34, v34
    v_exp_f32 v35, v35
    v_mfma_f32_32x32x8bf16_1k v[48:63], v[116:117], v[20:21], v[48:63]
    ds_read_b64 v[116:117], v29 offset:8064
    v_exp_f32 v36, v36
    v_exp_f32 v37, v37
    v_cvt_pk_bf16_f32 v64, v32, v33
    v_exp_f32 v38, v38
    v_exp_f32 v39, v39
    v_cvt_pk_bf16_f32 v65, v34, v35
    v_mfma_f32_32x32x16_bf16 v[96:111], v[128:131], v[72:75], v[96:111]
    v_exp_f32 v40, v40
    v_exp_f32 v41, v41
    v_cvt_pk_bf16_f32 v66, v36, v37
    v_exp_f32 v42, v42
    v_exp_f32 v43, v43
    v_cvt_pk_bf16_f32 v67, v38, v39
    v_mfma_f32_32x32x16_bf16 v[96:111], v[132:135], v[76:79], v[96:111]
    v_exp_f32 v44, v44
    v_exp_f32 v45, v45
    v_cvt_pk_bf16_f32 v68, v40, v41
    v_exp_f32 v46, v46
    v_exp_f32 v47, v47
    v_cvt_pk_bf16_f32 v69, v42, v43
    v_cvt_pk_bf16_f32 v70, v44, v45
    v_cvt_pk_bf16_f32 v71, v46, v47
    s_waitcnt lgkmcnt(0)
    v_mfma_f32_32x32x16_bf16 v[32:47], v[112:115], v[10:13], 0
    ds_read_b128 v[128:131], v31 offset:8064
    v_exp_f32 v48, v48
    v_exp_f32 v49, v49
    v_exp_f32 v50, v50
    v_exp_f32 v51, v51
    v_mfma_f32_32x32x8bf16_1k v[32:47], v[116:117], v[14:15], v[32:47]
    ds_read_b128 v[132:135], v31 offset:8768
    v_exp_f32 v52, v52
    v_exp_f32 v53, v53
    v_cvt_pk_bf16_f32 v72, v48, v49
    v_exp_f32 v54, v54
    v_exp_f32 v55, v55
    v_cvt_pk_bf16_f32 v73, v50, v51
    v_mfma_f32_32x32x16_bf16 v[80:95], v[120:123], v[64:67], v[80:95]
    v_exp_f32 v56, v56
    v_exp_f32 v57, v57
    v_cvt_pk_bf16_f32 v74, v52, v53
    v_exp_f32 v58, v58
    v_exp_f32 v59, v59
    v_cvt_pk_bf16_f32 v75, v54, v55
    v_mfma_f32_32x32x16_bf16 v[80:95], v[124:127], v[68:71], v[80:95]
    v_exp_f32 v60, v60
    v_exp_f32 v61, v61
    v_cvt_pk_bf16_f32 v76, v56, v57
    v_exp_f32 v62, v62
    v_exp_f32 v63, v63
    v_cvt_pk_bf16_f32 v77, v58, v59
    v_cvt_pk_bf16_f32 v78, v60, v61
    v_cvt_pk_bf16_f32 v79, v62, v63
    v_mfma_f32_32x32x16_bf16 v[48:63], v[112:115], v[16:19], 0
    ds_read_b128 v[112:115], v27 offset:10752
    v_exp_f32 v32, v32
    v_exp_f32 v33, v33
    v_exp_f32 v34, v34
    v_exp_f32 v35, v35
    v_mfma_f32_32x32x8bf16_1k v[48:63], v[116:117], v[20:21], v[48:63]
    ds_read_b64 v[116:117], v29 offset:10752
    v_exp_f32 v36, v36
    v_exp_f32 v37, v37
    v_cvt_pk_bf16_f32 v64, v32, v33
    v_exp_f32 v38, v38
    v_exp_f32 v39, v39
    v_cvt_pk_bf16_f32 v65, v34, v35
    v_mfma_f32_32x32x16_bf16 v[96:111], v[120:123], v[72:75], v[96:111]
    v_exp_f32 v40, v40
    v_exp_f32 v41, v41
    v_cvt_pk_bf16_f32 v66, v36, v37
    v_exp_f32 v42, v42
    v_exp_f32 v43, v43
    v_cvt_pk_bf16_f32 v67, v38, v39
    v_mfma_f32_32x32x16_bf16 v[96:111], v[124:127], v[76:79], v[96:111]
    v_exp_f32 v44, v44
    v_exp_f32 v45, v45
    v_cvt_pk_bf16_f32 v68, v40, v41
    v_exp_f32 v46, v46
    v_exp_f32 v47, v47
    v_cvt_pk_bf16_f32 v69, v42, v43
    v_cvt_pk_bf16_f32 v70, v44, v45
    v_cvt_pk_bf16_f32 v71, v46, v47
    s_waitcnt lgkmcnt(0)
    v_mfma_f32_32x32x16_bf16 v[32:47], v[112:115], v[10:13], 0
    ds_read_b128 v[120:123], v31 offset:10752
    v_exp_f32 v48, v48
    v_exp_f32 v49, v49
    v_exp_f32 v50, v50
    v_exp_f32 v51, v51
    v_mfma_f32_32x32x8bf16_1k v[32:47], v[116:117], v[14:15], v[32:47]
    ds_read_b128 v[124:127], v31 offset:11456
    v_exp_f32 v52, v52
    v_exp_f32 v53, v53
    v_cvt_pk_bf16_f32 v72, v48, v49
    v_exp_f32 v54, v54
    v_exp_f32 v55, v55
    v_cvt_pk_bf16_f32 v73, v50, v51
    v_mfma_f32_32x32x16_bf16 v[80:95], v[128:131], v[64:67], v[80:95]
    v_exp_f32 v56, v56
    v_exp_f32 v57, v57
    v_cvt_pk_bf16_f32 v74, v52, v53
    v_exp_f32 v58, v58
    v_exp_f32 v59, v59
    v_cvt_pk_bf16_f32 v75, v54, v55
    v_mfma_f32_32x32x16_bf16 v[80:95], v[132:135], v[68:71], v[80:95]
    v_exp_f32 v60, v60
    v_exp_f32 v61, v61
    v_cvt_pk_bf16_f32 v76, v56, v57
    v_exp_f32 v62, v62
    v_exp_f32 v63, v63
    v_cvt_pk_bf16_f32 v77, v58, v59
    v_cvt_pk_bf16_f32 v78, v60, v61
    v_cvt_pk_bf16_f32 v79, v62, v63
    v_mfma_f32_32x32x16_bf16 v[48:63], v[112:115], v[16:19], 0
    ds_read_b128 v[112:115], v27 offset:13440
    v_exp_f32 v32, v32
    v_exp_f32 v33, v33
    v_exp_f32 v34, v34
    v_exp_f32 v35, v35
    v_mfma_f32_32x32x8bf16_1k v[48:63], v[116:117], v[20:21], v[48:63]
    ds_read_b64 v[116:117], v29 offset:13440
    v_exp_f32 v36, v36
    v_exp_f32 v37, v37
    v_cvt_pk_bf16_f32 v64, v32, v33
    v_exp_f32 v38, v38
    v_exp_f32 v39, v39
    v_cvt_pk_bf16_f32 v65, v34, v35
    v_mfma_f32_32x32x16_bf16 v[96:111], v[128:131], v[72:75], v[96:111]
    v_exp_f32 v40, v40
    v_exp_f32 v41, v41
    v_cvt_pk_bf16_f32 v66, v36, v37
    v_exp_f32 v42, v42
    v_exp_f32 v43, v43
    v_cvt_pk_bf16_f32 v67, v38, v39
    v_mfma_f32_32x32x16_bf16 v[96:111], v[132:135], v[76:79], v[96:111]
    v_exp_f32 v44, v44
    v_exp_f32 v45, v45
    v_cvt_pk_bf16_f32 v68, v40, v41
    v_exp_f32 v46, v46
    v_exp_f32 v47, v47
    v_cvt_pk_bf16_f32 v69, v42, v43
    v_cvt_pk_bf16_f32 v70, v44, v45
    v_cvt_pk_bf16_f32 v71, v46, v47
    s_waitcnt lgkmcnt(0)
    v_mfma_f32_32x32x16_bf16 v[32:47], v[112:115], v[10:13], 0
    ds_read_b128 v[128:131], v31 offset:13440
    v_exp_f32 v48, v48
    v_exp_f32 v49, v49
    v_exp_f32 v50, v50
    v_exp_f32 v51, v51
    v_mfma_f32_32x32x8bf16_1k v[32:47], v[116:117], v[14:15], v[32:47]
    ds_read_b128 v[132:135], v31 offset:14144
    v_exp_f32 v52, v52
    v_exp_f32 v53, v53
    v_cvt_pk_bf16_f32 v72, v48, v49
    v_exp_f32 v54, v54
    v_exp_f32 v55, v55
    v_cvt_pk_bf16_f32 v73, v50, v51
    v_mfma_f32_32x32x16_bf16 v[80:95], v[120:123], v[64:67], v[80:95]
    v_exp_f32 v56, v56
    v_exp_f32 v57, v57
    v_cvt_pk_bf16_f32 v74, v52, v53
    v_exp_f32 v58, v58
    v_exp_f32 v59, v59
    v_cvt_pk_bf16_f32 v75, v54, v55
    v_mfma_f32_32x32x16_bf16 v[80:95], v[124:127], v[68:71], v[80:95]
    v_exp_f32 v60, v60
    v_exp_f32 v61, v61
    v_cvt_pk_bf16_f32 v76, v56, v57
    v_exp_f32 v62, v62
    v_exp_f32 v63, v63
    v_cvt_pk_bf16_f32 v77, v58, v59
    v_cvt_pk_bf16_f32 v78, v60, v61
    v_cvt_pk_bf16_f32 v79, v62, v63
    v_mfma_f32_32x32x16_bf16 v[48:63], v[112:115], v[16:19], 0
    ds_read_b128 v[112:115], v27 offset:16128
    v_exp_f32 v32, v32
    v_exp_f32 v33, v33
    v_exp_f32 v34, v34
    v_exp_f32 v35, v35
    v_mfma_f32_32x32x8bf16_1k v[48:63], v[116:117], v[20:21], v[48:63]
    ds_read_b64 v[116:117], v29 offset:16128
    v_exp_f32 v36, v36
    v_exp_f32 v37, v37
    v_cvt_pk_bf16_f32 v64, v32, v33
    v_exp_f32 v38, v38
    v_exp_f32 v39, v39
    v_cvt_pk_bf16_f32 v65, v34, v35
    v_mfma_f32_32x32x16_bf16 v[96:111], v[120:123], v[72:75], v[96:111]
    v_exp_f32 v40, v40
    v_exp_f32 v41, v41
    v_cvt_pk_bf16_f32 v66, v36, v37
    v_exp_f32 v42, v42
    v_exp_f32 v43, v43
    v_cvt_pk_bf16_f32 v67, v38, v39
    v_mfma_f32_32x32x16_bf16 v[96:111], v[124:127], v[76:79], v[96:111]
    v_exp_f32 v44, v44
    v_exp_f32 v45, v45
    v_cvt_pk_bf16_f32 v68, v40, v41
    v_exp_f32 v46, v46
    v_exp_f32 v47, v47
    v_cvt_pk_bf16_f32 v69, v42, v43
    v_cvt_pk_bf16_f32 v70, v44, v45
    v_cvt_pk_bf16_f32 v71, v46, v47
    s_waitcnt lgkmcnt(0)
    v_mfma_f32_32x32x16_bf16 v[32:47], v[112:115], v[10:13], 0
    ds_read_b128 v[120:123], v31 offset:16128
    v_exp_f32 v48, v48
    v_exp_f32 v49, v49
    v_exp_f32 v50, v50
    v_exp_f32 v51, v51
    v_mfma_f32_32x32x8bf16_1k v[32:47], v[116:117], v[14:15], v[32:47]
    ds_read_b128 v[124:127], v31 offset:16832
    v_exp_f32 v52, v52
    v_exp_f32 v53, v53
    v_cvt_pk_bf16_f32 v72, v48, v49
    v_exp_f32 v54, v54
    v_exp_f32 v55, v55
    v_cvt_pk_bf16_f32 v73, v50, v51
    v_mfma_f32_32x32x16_bf16 v[80:95], v[128:131], v[64:67], v[80:95]
    v_exp_f32 v56, v56
    v_exp_f32 v57, v57
    v_cvt_pk_bf16_f32 v74, v52, v53
    v_exp_f32 v58, v58
    v_exp_f32 v59, v59
    v_cvt_pk_bf16_f32 v75, v54, v55
    v_mfma_f32_32x32x16_bf16 v[80:95], v[132:135], v[68:71], v[80:95]
    v_exp_f32 v60, v60
    v_exp_f32 v61, v61
    v_cvt_pk_bf16_f32 v76, v56, v57
    v_exp_f32 v62, v62
    v_exp_f32 v63, v63
    v_cvt_pk_bf16_f32 v77, v58, v59
    v_cvt_pk_bf16_f32 v78, v60, v61
    v_cvt_pk_bf16_f32 v79, v62, v63
    v_mfma_f32_32x32x16_bf16 v[48:63], v[112:115], v[16:19], 0
    ds_read_b128 v[112:115], v27 offset:18816
    v_exp_f32 v32, v32
    v_exp_f32 v33, v33
    v_exp_f32 v34, v34
    v_exp_f32 v35, v35
    v_mfma_f32_32x32x8bf16_1k v[48:63], v[116:117], v[20:21], v[48:63]
    ds_read_b64 v[116:117], v29 offset:18816
    v_exp_f32 v36, v36
    v_exp_f32 v37, v37
    v_cvt_pk_bf16_f32 v64, v32, v33
    v_exp_f32 v38, v38
    v_exp_f32 v39, v39
    v_cvt_pk_bf16_f32 v65, v34, v35
    v_mfma_f32_32x32x16_bf16 v[96:111], v[128:131], v[72:75], v[96:111]
    v_exp_f32 v40, v40
    v_exp_f32 v41, v41
    v_cvt_pk_bf16_f32 v66, v36, v37
    v_exp_f32 v42, v42
    v_exp_f32 v43, v43
    v_cvt_pk_bf16_f32 v67, v38, v39
    v_mfma_f32_32x32x16_bf16 v[96:111], v[132:135], v[76:79], v[96:111]
    v_exp_f32 v44, v44
    v_exp_f32 v45, v45
    v_cvt_pk_bf16_f32 v68, v40, v41
    v_exp_f32 v46, v46
    v_exp_f32 v47, v47
    v_cvt_pk_bf16_f32 v69, v42, v43
    v_cvt_pk_bf16_f32 v70, v44, v45
    v_cvt_pk_bf16_f32 v71, v46, v47
    s_waitcnt lgkmcnt(0)
    v_mfma_f32_32x32x16_bf16 v[32:47], v[112:115], v[10:13], 0
    ds_read_b128 v[128:131], v31 offset:18816
    v_exp_f32 v48, v48
    v_exp_f32 v49, v49
    v_exp_f32 v50, v50
    v_exp_f32 v51, v51
    v_mfma_f32_32x32x8bf16_1k v[32:47], v[116:117], v[14:15], v[32:47]
    ds_read_b128 v[132:135], v31 offset:19520
    v_exp_f32 v52, v52
    v_exp_f32 v53, v53
    v_cvt_pk_bf16_f32 v72, v48, v49
    v_exp_f32 v54, v54
    v_exp_f32 v55, v55
    v_cvt_pk_bf16_f32 v73, v50, v51
    v_mfma_f32_32x32x16_bf16 v[80:95], v[120:123], v[64:67], v[80:95]
    ds_read_b32 v2, v8 offset:8
    v_exp_f32 v56, v56
    v_exp_f32 v57, v57
    v_cvt_pk_bf16_f32 v74, v52, v53
    v_exp_f32 v58, v58
    v_exp_f32 v59, v59
    v_cvt_pk_bf16_f32 v75, v54, v55
    v_mfma_f32_32x32x16_bf16 v[80:95], v[124:127], v[68:71], v[80:95]
    v_exp_f32 v60, v60
    v_exp_f32 v61, v61
    v_cvt_pk_bf16_f32 v76, v56, v57
    v_exp_f32 v62, v62
    v_exp_f32 v63, v63
    v_cvt_pk_bf16_f32 v77, v58, v59
    v_cvt_pk_bf16_f32 v78, v60, v61
    v_cvt_pk_bf16_f32 v79, v62, v63
    v_mfma_f32_32x32x16_bf16 v[48:63], v[112:115], v[16:19], 0
    s_waitcnt lgkmcnt(0)
    s_mov_b64 exec, 1
    ds_add_u32 v8, v9 offset:20
    s_mov_b64 exec, -1
    v_cmp_eq_u32 vcc, 4, v2
    s_cbranch_vccz L_ring1
L_ring1_ok:
    ds_read_b128 v[112:115], v26 offset:0
    v_exp_f32 v32, v32
    v_exp_f32 v33, v33
    v_exp_f32 v34, v34
    v_exp_f32 v35, v35
    v_mfma_f32_32x32x8bf16_1k v[48:63], v[116:117], v[20:21], v[48:63]
    ds_read_b64 v[116:117], v28 offset:0
    v_exp_f32 v36, v36
    v_exp_f32 v37, v37
    v_cvt_pk_bf16_f32 v64, v32, v33
    v_exp_f32 v38, v38
    v_exp_f32 v39, v39
    v_cvt_pk_bf16_f32 v65, v34, v35
    v_mfma_f32_32x32x16_bf16 v[96:111], v[120:123], v[72:75], v[96:111]
    v_exp_f32 v40, v40
    v_exp_f32 v41, v41
    v_cvt_pk_bf16_f32 v66, v36, v37
    v_exp_f32 v42, v42
    v_exp_f32 v43, v43
    v_cvt_pk_bf16_f32 v67, v38, v39
    v_mfma_f32_32x32x16_bf16 v[96:111], v[124:127], v[76:79], v[96:111]
    v_exp_f32 v44, v44
    v_exp_f32 v45, v45
    v_cvt_pk_bf16_f32 v68, v40, v41
    v_exp_f32 v46, v46
    v_exp_f32 v47, v47
    v_cvt_pk_bf16_f32 v69, v42, v43
    v_cvt_pk_bf16_f32 v70, v44, v45
    v_cvt_pk_bf16_f32 v71, v46, v47
    s_waitcnt lgkmcnt(0)
    v_mfma_f32_32x32x16_bf16 v[32:47], v[112:115], v[10:13], 0
    ds_read_b128 v[120:123], v30 offset:0
    v_exp_f32 v48, v48
    v_exp_f32 v49, v49
    v_exp_f32 v50, v50
    v_exp_f32 v51, v51
    v_mfma_f32_32x32x8bf16_1k v[32:47], v[116:117], v[14:15], v[32:47]
    ds_read_b128 v[124:127], v30 offset:704
    v_exp_f32 v52, v52
    v_exp_f32 v53, v53
    v_cvt_pk_bf16_f32 v72, v48, v49
    v_exp_f32 v54, v54
    v_exp_f32 v55, v55
    v_cvt_pk_bf16_f32 v73, v50, v51
    v_mfma_f32_32x32x16_bf16 v[80:95], v[128:131], v[64:67], v[80:95]
    v_exp_f32 v56, v56
    v_exp_f32 v57, v57
    v_cvt_pk_bf16_f32 v74, v52, v53
    v_exp_f32 v58, v58
    v_exp_f32 v59, v59
    v_cvt_pk_bf16_f32 v75, v54, v55
    v_mfma_f32_32x32x16_bf16 v[80:95], v[132:135], v[68:71], v[80:95]
    v_exp_f32 v60, v60
    v_exp_f32 v61, v61
    v_cvt_pk_bf16_f32 v76, v56, v57
    v_exp_f32 v62, v62
    v_exp_f32 v63, v63
    v_cvt_pk_bf16_f32 v77, v58, v59
    v_cvt_pk_bf16_f32 v78, v60, v61
    v_cvt_pk_bf16_f32 v79, v62, v63
    v_mfma_f32_32x32x16_bf16 v[48:63], v[112:115], v[16:19], 0
    ds_read_b128 v[112:115], v26 offset:2688
    v_exp_f32 v32, v32
    v_exp_f32 v33, v33
    v_exp_f32 v34, v34
    v_exp_f32 v35, v35
    v_mfma_f32_32x32x8bf16_1k v[48:63], v[116:117], v[20:21], v[48:63]
    ds_read_b64 v[116:117], v28 offset:2688
    v_exp_f32 v36, v36
    v_exp_f32 v37, v37
    v_cvt_pk_bf16_f32 v64, v32, v33
    v_exp_f32 v38, v38
    v_exp_f32 v39, v39
    v_cvt_pk_bf16_f32 v65, v34, v35
    v_mfma_f32_32x32x16_bf16 v[96:111], v[128:131], v[72:75], v[96:111]
    v_exp_f32 v40, v40
    v_exp_f32 v41, v41
    v_cvt_pk_bf16_f32 v66, v36, v37
    v_exp_f32 v42, v42
    v_exp_f32 v43, v43
    v_cvt_pk_bf16_f32 v67, v38, v39
    v_mfma_f32_32x32x16_bf16 v[96:111], v[132:135], v[76:79], v[96:111]
    v_exp_f32 v44, v44
    v_exp_f32 v45, v45
    v_cvt_pk_bf16_f32 v68, v40, v41
    v_exp_f32 v46, v46
    v_exp_f32 v47, v47
    v_cvt_pk_bf16_f32 v69, v42, v43
    v_cvt_pk_bf16_f32 v70, v44, v45
    v_cvt_pk_bf16_f32 v71, v46, v47
    s_waitcnt lgkmcnt(0)
    v_mfma_f32_32x32x16_bf16 v[32:47], v[112:115], v[10:13], 0
    ds_read_b128 v[128:131], v30 offset:2688
    v_exp_f32 v48, v48
    v_exp_f32 v49, v49
    v_exp_f32 v50, v50
    v_exp_f32 v51, v51
    v_mfma_f32_32x32x8bf16_1k v[32:47], v[116:117], v[14:15], v[32:47]
    ds_read_b128 v[132:135], v30 offset:3392
    v_exp_f32 v52, v52
    v_exp_f32 v53, v53
    v_cvt_pk_bf16_f32 v72, v48, v49
    v_exp_f32 v54, v54
    v_exp_f32 v55, v55
    v_cvt_pk_bf16_f32 v73, v50, v51
    v_mfma_f32_32x32x16_bf16 v[80:95], v[120:123], v[64:67], v[80:95]
    v_exp_f32 v56, v56
    v_exp_f32 v57, v57
    v_cvt_pk_bf16_f32 v74, v52, v53
    v_exp_f32 v58, v58
    v_exp_f32 v59, v59
    v_cvt_pk_bf16_f32 v75, v54, v55
    v_mfma_f32_32x32x16_bf16 v[80:95], v[124:127], v[68:71], v[80:95]
    v_exp_f32 v60, v60
    v_exp_f32 v61, v61
    v_cvt_pk_bf16_f32 v76, v56, v57
    v_exp_f32 v62, v62
    v_exp_f32 v63, v63
    v_cvt_pk_bf16_f32 v77, v58, v59
    v_cvt_pk_bf16_f32 v78, v60, v61
    v_cvt_pk_bf16_f32 v79, v62, v63
    v_mfma_f32_32x32x16_bf16 v[48:63], v[112:115], v[16:19], 0
    ds_read_b128 v[112:115], v26 offset:5376
    v_exp_f32 v32, v32
    v_exp_f32 v33, v33
    v_exp_f32 v34, v34
    v_exp_f32 v35, v35
    v_mfma_f32_32x32x8bf16_1k v[48:63], v[116:117], v[20:21], v[48:63]
    ds_read_b64 v[116:117], v28 offset:5376
    v_exp_f32 v36, v36
    v_exp_f32 v37, v37
    v_cvt_pk_bf16_f32 v64, v32, v33
    v_exp_f32 v38, v38
    v_exp_f32 v39, v39
    v_cvt_pk_bf16_f32 v65, v34, v35
    v_mfma_f32_32x32x16_bf16 v[96:111], v[120:123], v[72:75], v[96:111]
    v_exp_f32 v40, v40
    v_exp_f32 v41, v41
    v_cvt_pk_bf16_f32 v66, v36, v37
    v_exp_f32 v42, v42
    v_exp_f32 v43, v43
    v_cvt_pk_bf16_f32 v67, v38, v39
    v_mfma_f32_32x32x16_bf16 v[96:111], v[124:127], v[76:79], v[96:111]
    v_exp_f32 v44, v44
    v_exp_f32 v45, v45
    v_cvt_pk_bf16_f32 v68, v40, v41
    v_exp_f32 v46, v46
    v_exp_f32 v47, v47
    v_cvt_pk_bf16_f32 v69, v42, v43
    v_cvt_pk_bf16_f32 v70, v44, v45
    v_cvt_pk_bf16_f32 v71, v46, v47
    s_waitcnt lgkmcnt(0)
    v_mfma_f32_32x32x16_bf16 v[32:47], v[112:115], v[10:13], 0
    ds_read_b128 v[120:123], v30 offset:5376
    v_exp_f32 v48, v48
    v_exp_f32 v49, v49
    v_exp_f32 v50, v50
    v_exp_f32 v51, v51
    v_mfma_f32_32x32x8bf16_1k v[32:47], v[116:117], v[14:15], v[32:47]
    ds_read_b128 v[124:127], v30 offset:6080
    v_exp_f32 v52, v52
    v_exp_f32 v53, v53
    v_cvt_pk_bf16_f32 v72, v48, v49
    v_exp_f32 v54, v54
    v_exp_f32 v55, v55
    v_cvt_pk_bf16_f32 v73, v50, v51
    v_mfma_f32_32x32x16_bf16 v[80:95], v[128:131], v[64:67], v[80:95]
    v_exp_f32 v56, v56
    v_exp_f32 v57, v57
    v_cvt_pk_bf16_f32 v74, v52, v53
    v_exp_f32 v58, v58
    v_exp_f32 v59, v59
    v_cvt_pk_bf16_f32 v75, v54, v55
    v_mfma_f32_32x32x16_bf16 v[80:95], v[132:135], v[68:71], v[80:95]
    v_exp_f32 v60, v60
    v_exp_f32 v61, v61
    v_cvt_pk_bf16_f32 v76, v56, v57
    v_exp_f32 v62, v62
    v_exp_f32 v63, v63
    v_cvt_pk_bf16_f32 v77, v58, v59
    v_cvt_pk_bf16_f32 v78, v60, v61
    v_cvt_pk_bf16_f32 v79, v62, v63
    v_mfma_f32_32x32x16_bf16 v[48:63], v[112:115], v[16:19], 0
    ds_read_b128 v[112:115], v26 offset:8064
    v_exp_f32 v32, v32
    v_exp_f32 v33, v33
    v_exp_f32 v34, v34
    v_exp_f32 v35, v35
    v_mfma_f32_32x32x8bf16_1k v[48:63], v[116:117], v[20:21], v[48:63]
    ds_read_b64 v[116:117], v28 offset:8064
    v_exp_f32 v36, v36
    v_exp_f32 v37, v37
    v_cvt_pk_bf16_f32 v64, v32, v33
    v_exp_f32 v38, v38
    v_exp_f32 v39, v39
    v_cvt_pk_bf16_f32 v65, v34, v35
    v_mfma_f32_32x32x16_bf16 v[96:111], v[128:131], v[72:75], v[96:111]
    v_exp_f32 v40, v40
    v_exp_f32 v41, v41
    v_cvt_pk_bf16_f32 v66, v36, v37
    v_exp_f32 v42, v42
    v_exp_f32 v43, v43
    v_cvt_pk_bf16_f32 v67, v38, v39
    v_mfma_f32_32x32x16_bf16 v[96:111], v[132:135], v[76:79], v[96:111]
    v_exp_f32 v44, v44
    v_exp_f32 v45, v45
    v_cvt_pk_bf16_f32 v68, v40, v41
    v_exp_f32 v46, v46
    v_exp_f32 v47, v47
    v_cvt_pk_bf16_f32 v69, v42, v43
    v_cvt_pk_bf16_f32 v70, v44, v45
    v_cvt_pk_bf16_f32 v71, v46, v47
    s_waitcnt lgkmcnt(0)
    v_mfma_f32_32x32x16_bf16 v[32:47], v[112:115], v[10:13], 0
    ds_read_b128 v[128:131], v30 offset:8064
    v_exp_f32 v48, v48
    v_exp_f32 v49, v49
    v_exp_f32 v50, v50
    v_exp_f32 v51, v51
    v_mfma_f32_32x32x8bf16_1k v[32:47], v[116:117], v[14:15], v[32:47]
    ds_read_b128 v[132:135], v30 offset:8768
    v_exp_f32 v52, v52
    v_exp_f32 v53, v53
    v_cvt_pk_bf16_f32 v72, v48, v49
    v_exp_f32 v54, v54
    v_exp_f32 v55, v55
    v_cvt_pk_bf16_f32 v73, v50, v51
    v_mfma_f32_32x32x16_bf16 v[80:95], v[120:123], v[64:67], v[80:95]
    v_exp_f32 v56, v56
    v_exp_f32 v57, v57
    v_cvt_pk_bf16_f32 v74, v52, v53
    v_exp_f32 v58, v58
    v_exp_f32 v59, v59
    v_cvt_pk_bf16_f32 v75, v54, v55
    v_mfma_f32_32x32x16_bf16 v[80:95], v[124:127], v[68:71], v[80:95]
    v_exp_f32 v60, v60
    v_exp_f32 v61, v61
    v_cvt_pk_bf16_f32 v76, v56, v57
    v_exp_f32 v62, v62
    v_exp_f32 v63, v63
    v_cvt_pk_bf16_f32 v77, v58, v59
    v_cvt_pk_bf16_f32 v78, v60, v61
    v_cvt_pk_bf16_f32 v79, v62, v63
    v_mfma_f32_32x32x16_bf16 v[48:63], v[112:115], v[16:19], 0
    ds_read_b128 v[112:115], v26 offset:10752
    v_exp_f32 v32, v32
    v_exp_f32 v33, v33
    v_exp_f32 v34, v34
    v_exp_f32 v35, v35
    v_mfma_f32_32x32x8bf16_1k v[48:63], v[116:117], v[20:21], v[48:63]
    ds_read_b64 v[116:117], v28 offset:10752
    v_exp_f32 v36, v36
    v_exp_f32 v37, v37
    v_cvt_pk_bf16_f32 v64, v32, v33
    v_exp_f32 v38, v38
    v_exp_f32 v39, v39
    v_cvt_pk_bf16_f32 v65, v34, v35
    v_mfma_f32_32x32x16_bf16 v[96:111], v[120:123], v[72:75], v[96:111]
    v_exp_f32 v40, v40
    v_exp_f32 v41, v41
    v_cvt_pk_bf16_f32 v66, v36, v37
    v_exp_f32 v42, v42
    v_exp_f32 v43, v43
    v_cvt_pk_bf16_f32 v67, v38, v39
    v_mfma_f32_32x32x16_bf16 v[96:111], v[124:127], v[76:79], v[96:111]
    v_exp_f32 v44, v44
    v_exp_f32 v45, v45
    v_cvt_pk_bf16_f32 v68, v40, v41
    v_exp_f32 v46, v46
    v_exp_f32 v47, v47
    v_cvt_pk_bf16_f32 v69, v42, v43
    v_cvt_pk_bf16_f32 v70, v44, v45
    v_cvt_pk_bf16_f32 v71, v46, v47
    s_waitcnt lgkmcnt(0)
    v_mfma_f32_32x32x16_bf16 v[32:47], v[112:115], v[10:13], 0
    ds_read_b128 v[120:123], v30 offset:10752
    v_exp_f32 v48, v48
    v_exp_f32 v49, v49
    v_exp_f32 v50, v50
    v_exp_f32 v51, v51
    v_mfma_f32_32x32x8bf16_1k v[32:47], v[116:117], v[14:15], v[32:47]
    ds_read_b128 v[124:127], v30 offset:11456
    v_exp_f32 v52, v52
    v_exp_f32 v53, v53
    v_cvt_pk_bf16_f32 v72, v48, v49
    v_exp_f32 v54, v54
    v_exp_f32 v55, v55
    v_cvt_pk_bf16_f32 v73, v50, v51
    v_mfma_f32_32x32x16_bf16 v[80:95], v[128:131], v[64:67], v[80:95]
    v_exp_f32 v56, v56
    v_exp_f32 v57, v57
    v_cvt_pk_bf16_f32 v74, v52, v53
    v_exp_f32 v58, v58
    v_exp_f32 v59, v59
    v_cvt_pk_bf16_f32 v75, v54, v55
    v_mfma_f32_32x32x16_bf16 v[80:95], v[132:135], v[68:71], v[80:95]
    v_exp_f32 v60, v60
    v_exp_f32 v61, v61
    v_cvt_pk_bf16_f32 v76, v56, v57
    v_exp_f32 v62, v62
    v_exp_f32 v63, v63
    v_cvt_pk_bf16_f32 v77, v58, v59
    v_cvt_pk_bf16_f32 v78, v60, v61
    v_cvt_pk_bf16_f32 v79, v62, v63
    v_mfma_f32_32x32x16_bf16 v[48:63], v[112:115], v[16:19], 0
    ds_read_b128 v[112:115], v26 offset:13440
    v_exp_f32 v32, v32
    v_exp_f32 v33, v33
    v_exp_f32 v34, v34
    v_exp_f32 v35, v35
    v_mfma_f32_32x32x8bf16_1k v[48:63], v[116:117], v[20:21], v[48:63]
    ds_read_b64 v[116:117], v28 offset:13440
    v_exp_f32 v36, v36
    v_exp_f32 v37, v37
    v_cvt_pk_bf16_f32 v64, v32, v33
    v_exp_f32 v38, v38
    v_exp_f32 v39, v39
    v_cvt_pk_bf16_f32 v65, v34, v35
    v_mfma_f32_32x32x16_bf16 v[96:111], v[128:131], v[72:75], v[96:111]
    v_exp_f32 v40, v40
    v_exp_f32 v41, v41
    v_cvt_pk_bf16_f32 v66, v36, v37
    v_exp_f32 v42, v42
    v_exp_f32 v43, v43
    v_cvt_pk_bf16_f32 v67, v38, v39
    v_mfma_f32_32x32x16_bf16 v[96:111], v[132:135], v[76:79], v[96:111]
    v_exp_f32 v44, v44
    v_exp_f32 v45, v45
    v_cvt_pk_bf16_f32 v68, v40, v41
    v_exp_f32 v46, v46
    v_exp_f32 v47, v47
    v_cvt_pk_bf16_f32 v69, v42, v43
    v_cvt_pk_bf16_f32 v70, v44, v45
    v_cvt_pk_bf16_f32 v71, v46, v47
    s_waitcnt lgkmcnt(0)
    v_mfma_f32_32x32x16_bf16 v[32:47], v[112:115], v[10:13], 0
    ds_read_b128 v[128:131], v30 offset:13440
    v_exp_f32 v48, v48
    v_exp_f32 v49, v49
    v_exp_f32 v50, v50
    v_exp_f32 v51, v51
    v_mfma_f32_32x32x8bf16_1k v[32:47], v[116:117], v[14:15], v[32:47]
    ds_read_b128 v[132:135], v30 offset:14144
    v_exp_f32 v52, v52
    v_exp_f32 v53, v53
    v_cvt_pk_bf16_f32 v72, v48, v49
    v_exp_f32 v54, v54
    v_exp_f32 v55, v55
    v_cvt_pk_bf16_f32 v73, v50, v51
    v_mfma_f32_32x32x16_bf16 v[80:95], v[120:123], v[64:67], v[80:95]
    v_exp_f32 v56, v56
    v_exp_f32 v57, v57
    v_cvt_pk_bf16_f32 v74, v52, v53
    v_exp_f32 v58, v58
    v_exp_f32 v59, v59
    v_cvt_pk_bf16_f32 v75, v54, v55
    v_mfma_f32_32x32x16_bf16 v[80:95], v[124:127], v[68:71], v[80:95]
    v_exp_f32 v60, v60
    v_exp_f32 v61, v61
    v_cvt_pk_bf16_f32 v76, v56, v57
    v_exp_f32 v62, v62
    v_exp_f32 v63, v63
    v_cvt_pk_bf16_f32 v77, v58, v59
    v_cvt_pk_bf16_f32 v78, v60, v61
    v_cvt_pk_bf16_f32 v79, v62, v63
    v_mfma_f32_32x32x16_bf16 v[48:63], v[112:115], v[16:19], 0
    ds_read_b128 v[112:115], v26 offset:16128
    v_exp_f32 v32, v32
    v_exp_f32 v33, v33
    v_exp_f32 v34, v34
    v_exp_f32 v35, v35
    v_mfma_f32_32x32x8bf16_1k v[48:63], v[116:117], v[20:21], v[48:63]
    ds_read_b64 v[116:117], v28 offset:16128
    v_exp_f32 v36, v36
    v_exp_f32 v37, v37
    v_cvt_pk_bf16_f32 v64, v32, v33
    v_exp_f32 v38, v38
    v_exp_f32 v39, v39
    v_cvt_pk_bf16_f32 v65, v34, v35
    v_mfma_f32_32x32x16_bf16 v[96:111], v[120:123], v[72:75], v[96:111]
    v_exp_f32 v40, v40
    v_exp_f32 v41, v41
    v_cvt_pk_bf16_f32 v66, v36, v37
    v_exp_f32 v42, v42
    v_exp_f32 v43, v43
    v_cvt_pk_bf16_f32 v67, v38, v39
    v_mfma_f32_32x32x16_bf16 v[96:111], v[124:127], v[76:79], v[96:111]
    v_exp_f32 v44, v44
    v_exp_f32 v45, v45
    v_cvt_pk_bf16_f32 v68, v40, v41
    v_exp_f32 v46, v46
    v_exp_f32 v47, v47
    v_cvt_pk_bf16_f32 v69, v42, v43
    v_cvt_pk_bf16_f32 v70, v44, v45
    v_cvt_pk_bf16_f32 v71, v46, v47
    s_waitcnt lgkmcnt(0)
    v_mfma_f32_32x32x16_bf16 v[32:47], v[112:115], v[10:13], 0
    ds_read_b128 v[120:123], v30 offset:16128
    v_exp_f32 v48, v48
    v_exp_f32 v49, v49
    v_exp_f32 v50, v50
    v_exp_f32 v51, v51
    v_mfma_f32_32x32x8bf16_1k v[32:47], v[116:117], v[14:15], v[32:47]
    ds_read_b128 v[124:127], v30 offset:16832
    v_exp_f32 v52, v52
    v_exp_f32 v53, v53
    v_cvt_pk_bf16_f32 v72, v48, v49
    v_exp_f32 v54, v54
    v_exp_f32 v55, v55
    v_cvt_pk_bf16_f32 v73, v50, v51
    v_mfma_f32_32x32x16_bf16 v[80:95], v[128:131], v[64:67], v[80:95]
    v_exp_f32 v56, v56
    v_exp_f32 v57, v57
    v_cvt_pk_bf16_f32 v74, v52, v53
    v_exp_f32 v58, v58
    v_exp_f32 v59, v59
    v_cvt_pk_bf16_f32 v75, v54, v55
    v_mfma_f32_32x32x16_bf16 v[80:95], v[132:135], v[68:71], v[80:95]
    v_exp_f32 v60, v60
    v_exp_f32 v61, v61
    v_cvt_pk_bf16_f32 v76, v56, v57
    v_exp_f32 v62, v62
    v_exp_f32 v63, v63
    v_cvt_pk_bf16_f32 v77, v58, v59
    v_cvt_pk_bf16_f32 v78, v60, v61
    v_cvt_pk_bf16_f32 v79, v62, v63
    v_mfma_f32_32x32x16_bf16 v[48:63], v[112:115], v[16:19], 0
    ds_read_b128 v[112:115], v26 offset:18816
    v_exp_f32 v32, v32
    v_exp_f32 v33, v33
    v_exp_f32 v34, v34
    v_exp_f32 v35, v35
    v_mfma_f32_32x32x8bf16_1k v[48:63], v[116:117], v[20:21], v[48:63]
    ds_read_b64 v[116:117], v28 offset:18816
    v_exp_f32 v36, v36
    v_exp_f32 v37, v37
    v_cvt_pk_bf16_f32 v64, v32, v33
    v_exp_f32 v38, v38
    v_exp_f32 v39, v39
    v_cvt_pk_bf16_f32 v65, v34, v35
    v_mfma_f32_32x32x16_bf16 v[96:111], v[128:131], v[72:75], v[96:111]
    v_exp_f32 v40, v40
    v_exp_f32 v41, v41
    v_cvt_pk_bf16_f32 v66, v36, v37
    v_exp_f32 v42, v42
    v_exp_f32 v43, v43
    v_cvt_pk_bf16_f32 v67, v38, v39
    v_mfma_f32_32x32x16_bf16 v[96:111], v[132:135], v[76:79], v[96:111]
    v_exp_f32 v44, v44
    v_exp_f32 v45, v45
    v_cvt_pk_bf16_f32 v68, v40, v41
    v_exp_f32 v46, v46
    v_exp_f32 v47, v47
    v_cvt_pk_bf16_f32 v69, v42, v43
    v_cvt_pk_bf16_f32 v70, v44, v45
    v_cvt_pk_bf16_f32 v71, v46, v47
    s_waitcnt lgkmcnt(0)
    v_mfma_f32_32x32x16_bf16 v[32:47], v[112:115], v[10:13], 0
    ds_read_b128 v[128:131], v30 offset:18816
    v_exp_f32 v48, v48
    v_exp_f32 v49, v49
    v_exp_f32 v50, v50
    v_exp_f32 v51, v51
    v_mfma_f32_32x32x8bf16_1k v[32:47], v[116:117], v[14:15], v[32:47]
    ds_read_b128 v[132:135], v30 offset:19520
    v_exp_f32 v52, v52
    v_exp_f32 v53, v53
    v_cvt_pk_bf16_f32 v72, v48, v49
    v_exp_f32 v54, v54
    v_exp_f32 v55, v55
    v_cvt_pk_bf16_f32 v73, v50, v51
    v_mfma_f32_32x32x16_bf16 v[80:95], v[120:123], v[64:67], v[80:95]
    ds_read_b32 v2, v8 offset:12
    v_exp_f32 v56, v56
    v_exp_f32 v57, v57
    v_cvt_pk_bf16_f32 v74, v52, v53
    v_exp_f32 v58, v58
    v_exp_f32 v59, v59
    v_cvt_pk_bf16_f32 v75, v54, v55
    v_mfma_f32_32x32x16_bf16 v[80:95], v[124:127], v[68:71], v[80:95]
    v_exp_f32 v60, v60
    v_exp_f32 v61, v61
    v_cvt_pk_bf16_f32 v76, v56, v57
    v_exp_f32 v62, v62
    v_exp_f32 v63, v63
    v_cvt_pk_bf16_f32 v77, v58, v59
    v_cvt_pk_bf16_f32 v78, v60, v61
    v_cvt_pk_bf16_f32 v79, v62, v63
    v_mfma_f32_32x32x16_bf16 v[48:63], v[112:115], v[16:19], 0
    s_waitcnt lgkmcnt(0)
    s_mov_b64 exec, 1
    ds_add_u32 v8, v9 offset:24
    s_mov_b64 exec, -1
    v_cmp_eq_u32 vcc, 4, v2
    s_cbranch_vccz L_ring2
L_ring2_ok:
    ds_read_b128 v[112:115], v27 offset:0
    v_exp_f32 v32, v32
    v_exp_f32 v33, v33
    v_exp_f32 v34, v34
    v_exp_f32 v35, v35
    v_mfma_f32_32x32x8bf16_1k v[48:63], v[116:117], v[20:21], v[48:63]
    ds_read_b64 v[116:117], v29 offset:0
    v_exp_f32 v36, v36
    v_exp_f32 v37, v37
    v_cvt_pk_bf16_f32 v64, v32, v33
    v_exp_f32 v38, v38
    v_exp_f32 v39, v39
    v_cvt_pk_bf16_f32 v65, v34, v35
    v_mfma_f32_32x32x16_bf16 v[96:111], v[120:123], v[72:75], v[96:111]
    v_exp_f32 v40, v40
    v_exp_f32 v41, v41
    v_cvt_pk_bf16_f32 v66, v36, v37
    v_exp_f32 v42, v42
    v_exp_f32 v43, v43
    v_cvt_pk_bf16_f32 v67, v38, v39
    v_mfma_f32_32x32x16_bf16 v[96:111], v[124:127], v[76:79], v[96:111]
    v_exp_f32 v44, v44
    v_exp_f32 v45, v45
    v_cvt_pk_bf16_f32 v68, v40, v41
    v_exp_f32 v46, v46
    v_exp_f32 v47, v47
    v_cvt_pk_bf16_f32 v69, v42, v43
    v_cvt_pk_bf16_f32 v70, v44, v45
    v_cvt_pk_bf16_f32 v71, v46, v47
    s_waitcnt lgkmcnt(0)
    v_mfma_f32_32x32x16_bf16 v[32:47], v[112:115], v[10:13], 0
    ds_read_b128 v[120:123], v31 offset:0
    v_exp_f32 v48, v48
    v_exp_f32 v49, v49
    v_exp_f32 v50, v50
    v_exp_f32 v51, v51
    v_mfma_f32_32x32x8bf16_1k v[32:47], v[116:117], v[14:15], v[32:47]
    ds_read_b128 v[124:127], v31 offset:704
    v_exp_f32 v52, v52
    v_exp_f32 v53, v53
    v_cvt_pk_bf16_f32 v72, v48, v49
    v_exp_f32 v54, v54
    v_exp_f32 v55, v55
    v_cvt_pk_bf16_f32 v73, v50, v51
    v_mfma_f32_32x32x16_bf16 v[80:95], v[128:131], v[64:67], v[80:95]
    v_exp_f32 v56, v56
    v_exp_f32 v57, v57
    v_cvt_pk_bf16_f32 v74, v52, v53
    v_exp_f32 v58, v58
    v_exp_f32 v59, v59
    v_cvt_pk_bf16_f32 v75, v54, v55
    v_mfma_f32_32x32x16_bf16 v[80:95], v[132:135], v[68:71], v[80:95]
    v_exp_f32 v60, v60
    v_exp_f32 v61, v61
    v_cvt_pk_bf16_f32 v76, v56, v57
    v_exp_f32 v62, v62
    v_exp_f32 v63, v63
    v_cvt_pk_bf16_f32 v77, v58, v59
    v_cvt_pk_bf16_f32 v78, v60, v61
    v_cvt_pk_bf16_f32 v79, v62, v63
    v_mfma_f32_32x32x16_bf16 v[48:63], v[112:115], v[16:19], 0
    ds_read_b128 v[112:115], v27 offset:2688
    v_exp_f32 v32, v32
    v_exp_f32 v33, v33
    v_exp_f32 v34, v34
    v_exp_f32 v35, v35
    v_mfma_f32_32x32x8bf16_1k v[48:63], v[116:117], v[20:21], v[48:63]
    ds_read_b64 v[116:117], v29 offset:2688
    v_exp_f32 v36, v36
    v_exp_f32 v37, v37
    v_cvt_pk_bf16_f32 v64, v32, v33
    v_exp_f32 v38, v38
    v_exp_f32 v39, v39
    v_cvt_pk_bf16_f32 v65, v34, v35
    v_mfma_f32_32x32x16_bf16 v[96:111], v[128:131], v[72:75], v[96:111]
    v_exp_f32 v40, v40
    v_exp_f32 v41, v41
    v_cvt_pk_bf16_f32 v66, v36, v37
    v_exp_f32 v42, v42
    v_exp_f32 v43, v43
    v_cvt_pk_bf16_f32 v67, v38, v39
    v_mfma_f32_32x32x16_bf16 v[96:111], v[132:135], v[76:79], v[96:111]
    v_exp_f32 v44, v44
    v_exp_f32 v45, v45
    v_cvt_pk_bf16_f32 v68, v40, v41
    v_exp_f32 v46, v46
    v_exp_f32 v47, v47
    v_cvt_pk_bf16_f32 v69, v42, v43
    v_cvt_pk_bf16_f32 v70, v44, v45
    v_cvt_pk_bf16_f32 v71, v46, v47
    s_waitcnt lgkmcnt(0)
    v_mfma_f32_32x32x16_bf16 v[32:47], v[112:115], v[10:13], 0
    ds_read_b128 v[128:131], v31 offset:2688
    v_exp_f32 v48, v48
    v_exp_f32 v49, v49
    v_exp_f32 v50, v50
    v_exp_f32 v51, v51
    v_mfma_f32_32x32x8bf16_1k v[32:47], v[116:117], v[14:15], v[32:47]
    ds_read_b128 v[132:135], v31 offset:3392
    v_exp_f32 v52, v52
    v_exp_f32 v53, v53
    v_cvt_pk_bf16_f32 v72, v48, v49
    v_exp_f32 v54, v54
    v_exp_f32 v55, v55
    v_cvt_pk_bf16_f32 v73, v50, v51
    v_mfma_f32_32x32x16_bf16 v[80:95], v[120:123], v[64:67], v[80:95]
    v_exp_f32 v56, v56
    v_exp_f32 v57, v57
    v_cvt_pk_bf16_f32 v74, v52, v53
    v_exp_f32 v58, v58
    v_exp_f32 v59, v59
    v_cvt_pk_bf16_f32 v75, v54, v55
    v_mfma_f32_32x32x16_bf16 v[80:95], v[124:127], v[68:71], v[80:95]
    v_exp_f32 v60, v60
    v_exp_f32 v61, v61
    v_cvt_pk_bf16_f32 v76, v56, v57
    v_exp_f32 v62, v62
    v_exp_f32 v63, v63
    v_cvt_pk_bf16_f32 v77, v58, v59
    v_cvt_pk_bf16_f32 v78, v60, v61
    v_cvt_pk_bf16_f32 v79, v62, v63
    v_mfma_f32_32x32x16_bf16 v[48:63], v[112:115], v[16:19], 0
    ds_read_b128 v[112:115], v27 offset:5376
    v_exp_f32 v32, v32
    v_exp_f32 v33, v33
    v_exp_f32 v34, v34
    v_exp_f32 v35, v35
    v_mfma_f32_32x32x8bf16_1k v[48:63], v[116:117], v[20:21], v[48:63]
    ds_read_b64 v[116:117], v29 offset:5376
    v_exp_f32 v36, v36
    v_exp_f32 v37, v37
    v_cvt_pk_bf16_f32 v64, v32, v33
    v_exp_f32 v38, v38
    v_exp_f32 v39, v39
    v_cvt_pk_bf16_f32 v65, v34, v35
    v_mfma_f32_32x32x16_bf16 v[96:111], v[120:123], v[72:75], v[96:111]
    v_exp_f32 v40, v40
    v_exp_f32 v41, v41
    v_cvt_pk_bf16_f32 v66, v36, v37
    v_exp_f32 v42, v42
    v_exp_f32 v43, v43
    v_cvt_pk_bf16_f32 v67, v38, v39
    v_mfma_f32_32x32x16_bf16 v[96:111], v[124:127], v[76:79], v[96:111]
    v_exp_f32 v44, v44
    v_exp_f32 v45, v45
    v_cvt_pk_bf16_f32 v68, v40, v41
    v_exp_f32 v46, v46
    v_exp_f32 v47, v47
    v_cvt_pk_bf16_f32 v69, v42, v43
    v_cvt_pk_bf16_f32 v70, v44, v45
    v_cvt_pk_bf16_f32 v71, v46, v47
    s_waitcnt lgkmcnt(0)
    v_mfma_f32_32x32x16_bf16 v[32:47], v[112:115], v[10:13], 0
    ds_read_b128 v[120:123], v31 offset:5376
    v_exp_f32 v48, v48
    v_exp_f32 v49, v49
    v_exp_f32 v50, v50
    v_exp_f32 v51, v51
    v_mfma_f32_32x32x8bf16_1k v[32:47], v[116:117], v[14:15], v[32:47]
    ds_read_b128 v[124:127], v31 offset:6080
    v_exp_f32 v52, v52
    v_exp_f32 v53, v53
    v_cvt_pk_bf16_f32 v72, v48, v49
    v_exp_f32 v54, v54
    v_exp_f32 v55, v55
    v_cvt_pk_bf16_f32 v73, v50, v51
    v_mfma_f32_32x32x16_bf16 v[80:95], v[128:131], v[64:67], v[80:95]
    v_exp_f32 v56, v56
    v_exp_f32 v57, v57
    v_cvt_pk_bf16_f32 v74, v52, v53
    v_exp_f32 v58, v58
    v_exp_f32 v59, v59
    v_cvt_pk_bf16_f32 v75, v54, v55
    v_mfma_f32_32x32x16_bf16 v[80:95], v[132:135], v[68:71], v[80:95]
    v_exp_f32 v60, v60
    v_exp_f32 v61, v61
    v_cvt_pk_bf16_f32 v76, v56, v57
    v_exp_f32 v62, v62
    v_exp_f32 v63, v63
    v_cvt_pk_bf16_f32 v77, v58, v59
    v_cvt_pk_bf16_f32 v78, v60, v61
    v_cvt_pk_bf16_f32 v79, v62, v63
    v_mfma_f32_32x32x16_bf16 v[48:63], v[112:115], v[16:19], 0
    ds_read_b128 v[112:115], v27 offset:8064
    v_exp_f32 v32, v32
    v_exp_f32 v33, v33
    v_exp_f32 v34, v34
    v_exp_f32 v35, v35
    v_mfma_f32_32x32x8bf16_1k v[48:63], v[116:117], v[20:21], v[48:63]
    ds_read_b64 v[116:117], v29 offset:8064
    v_exp_f32 v36, v36
    v_exp_f32 v37, v37
    v_cvt_pk_bf16_f32 v64, v32, v33
    v_exp_f32 v38, v38
    v_exp_f32 v39, v39
    v_cvt_pk_bf16_f32 v65, v34, v35
    v_mfma_f32_32x32x16_bf16 v[96:111], v[128:131], v[72:75], v[96:111]
    v_exp_f32 v40, v40
    v_exp_f32 v41, v41
    v_cvt_pk_bf16_f32 v66, v36, v37
    v_exp_f32 v42, v42
    v_exp_f32 v43, v43
    v_cvt_pk_bf16_f32 v67, v38, v39
    v_mfma_f32_32x32x16_bf16 v[96:111], v[132:135], v[76:79], v[96:111]
    v_exp_f32 v44, v44
    v_exp_f32 v45, v45
    v_cvt_pk_bf16_f32 v68, v40, v41
    v_exp_f32 v46, v46
    v_exp_f32 v47, v47
    v_cvt_pk_bf16_f32 v69, v42, v43
    v_cvt_pk_bf16_f32 v70, v44, v45
    v_cvt_pk_bf16_f32 v71, v46, v47
    s_waitcnt lgkmcnt(0)
    v_mfma_f32_32x32x16_bf16 v[32:47], v[112:115], v[10:13], 0
    ds_read_b128 v[128:131], v31 offset:8064
    v_exp_f32 v48, v48
    v_exp_f32 v49, v49
    v_exp_f32 v50, v50
    v_exp_f32 v51, v51
    v_mfma_f32_32x32x8bf16_1k v[32:47], v[116:117], v[14:15], v[32:47]
    ds_read_b128 v[132:135], v31 offset:8768
    v_exp_f32 v52, v52
    v_exp_f32 v53, v53
    v_cvt_pk_bf16_f32 v72, v48, v49
    v_exp_f32 v54, v54
    v_exp_f32 v55, v55
    v_cvt_pk_bf16_f32 v73, v50, v51
    v_mfma_f32_32x32x16_bf16 v[80:95], v[120:123], v[64:67], v[80:95]
    v_exp_f32 v56, v56
    v_exp_f32 v57, v57
    v_cvt_pk_bf16_f32 v74, v52, v53
    v_exp_f32 v58, v58
    v_exp_f32 v59, v59
    v_cvt_pk_bf16_f32 v75, v54, v55
    v_mfma_f32_32x32x16_bf16 v[80:95], v[124:127], v[68:71], v[80:95]
    v_exp_f32 v60, v60
    v_exp_f32 v61, v61
    v_cvt_pk_bf16_f32 v76, v56, v57
    v_exp_f32 v62, v62
    v_exp_f32 v63, v63
    v_cvt_pk_bf16_f32 v77, v58, v59
    v_cvt_pk_bf16_f32 v78, v60, v61
    v_cvt_pk_bf16_f32 v79, v62, v63
    v_mfma_f32_32x32x16_bf16 v[48:63], v[112:115], v[16:19], 0
    ds_read_b128 v[112:115], v27 offset:10752
    v_exp_f32 v32, v32
    v_exp_f32 v33, v33
    v_exp_f32 v34, v34
    v_exp_f32 v35, v35
    v_mfma_f32_32x32x8bf16_1k v[48:63], v[116:117], v[20:21], v[48:63]
    ds_read_b64 v[116:117], v29 offset:10752
    v_exp_f32 v36, v36
    v_exp_f32 v37, v37
    v_cvt_pk_bf16_f32 v64, v32, v33
    v_exp_f32 v38, v38
    v_exp_f32 v39, v39
    v_cvt_pk_bf16_f32 v65, v34, v35
    v_mfma_f32_32x32x16_bf16 v[96:111], v[120:123], v[72:75], v[96:111]
    v_exp_f32 v40, v40
    v_exp_f32 v41, v41
    v_cvt_pk_bf16_f32 v66, v36, v37
    v_exp_f32 v42, v42
    v_exp_f32 v43, v43
    v_cvt_pk_bf16_f32 v67, v38, v39
    v_mfma_f32_32x32x16_bf16 v[96:111], v[124:127], v[76:79], v[96:111]
    v_exp_f32 v44, v44
    v_exp_f32 v45, v45
    v_cvt_pk_bf16_f32 v68, v40, v41
    v_exp_f32 v46, v46
    v_exp_f32 v47, v47
    v_cvt_pk_bf16_f32 v69, v42, v43
    v_cvt_pk_bf16_f32 v70, v44, v45
    v_cvt_pk_bf16_f32 v71, v46, v47
    s_waitcnt lgkmcnt(0)
    v_mfma_f32_32x32x16_bf16 v[32:47], v[112:115], v[10:13], 0
    ds_read_b128 v[120:123], v31 offset:10752
    v_exp_f32 v48, v48
    v_exp_f32 v49, v49
    v_exp_f32 v50, v50
    v_exp_f32 v51, v51
    v_mfma_f32_32x32x8bf16_1k v[32:47], v[116:117], v[14:15], v[32:47]
    ds_read_b128 v[124:127], v31 offset:11456
    v_exp_f32 v52, v52
    v_exp_f32 v53, v53
    v_cvt_pk_bf16_f32 v72, v48, v49
    v_exp_f32 v54, v54
    v_exp_f32 v55, v55
    v_cvt_pk_bf16_f32 v73, v50, v51
    v_mfma_f32_32x32x16_bf16 v[80:95], v[128:131], v[64:67], v[80:95]
    v_exp_f32 v56, v56
    v_exp_f32 v57, v57
    v_cvt_pk_bf16_f32 v74, v52, v53
    v_exp_f32 v58, v58
    v_exp_f32 v59, v59
    v_cvt_pk_bf16_f32 v75, v54, v55
    v_mfma_f32_32x32x16_bf16 v[80:95], v[132:135], v[68:71], v[80:95]
    v_exp_f32 v60, v60
    v_exp_f32 v61, v61
    v_cvt_pk_bf16_f32 v76, v56, v57
    v_exp_f32 v62, v62
    v_exp_f32 v63, v63
    v_cvt_pk_bf16_f32 v77, v58, v59
    v_cvt_pk_bf16_f32 v78, v60, v61
    v_cvt_pk_bf16_f32 v79, v62, v63
    v_mfma_f32_32x32x16_bf16 v[48:63], v[112:115], v[16:19], 0
    ds_read_b128 v[112:115], v27 offset:13440
    v_exp_f32 v32, v32
    v_exp_f32 v33, v33
    v_exp_f32 v34, v34
    v_exp_f32 v35, v35
    v_mfma_f32_32x32x8bf16_1k v[48:63], v[116:117], v[20:21], v[48:63]
    ds_read_b64 v[116:117], v29 offset:13440
    v_exp_f32 v36, v36
    v_exp_f32 v37, v37
    v_cvt_pk_bf16_f32 v64, v32, v33
    v_exp_f32 v38, v38
    v_exp_f32 v39, v39
    v_cvt_pk_bf16_f32 v65, v34, v35
    v_mfma_f32_32x32x16_bf16 v[96:111], v[128:131], v[72:75], v[96:111]
    v_exp_f32 v40, v40
    v_exp_f32 v41, v41
    v_cvt_pk_bf16_f32 v66, v36, v37
    v_exp_f32 v42, v42
    v_exp_f32 v43, v43
    v_cvt_pk_bf16_f32 v67, v38, v39
    v_mfma_f32_32x32x16_bf16 v[96:111], v[132:135], v[76:79], v[96:111]
    v_exp_f32 v44, v44
    v_exp_f32 v45, v45
    v_cvt_pk_bf16_f32 v68, v40, v41
    v_exp_f32 v46, v46
    v_exp_f32 v47, v47
    v_cvt_pk_bf16_f32 v69, v42, v43
    v_cvt_pk_bf16_f32 v70, v44, v45
    v_cvt_pk_bf16_f32 v71, v46, v47
    s_waitcnt lgkmcnt(0)
    v_mfma_f32_32x32x16_bf16 v[32:47], v[112:115], v[10:13], 0
    ds_read_b128 v[128:131], v31 offset:13440
    v_exp_f32 v48, v48
    v_exp_f32 v49, v49
    v_exp_f32 v50, v50
    v_exp_f32 v51, v51
    v_mfma_f32_32x32x8bf16_1k v[32:47], v[116:117], v[14:15], v[32:47]
    ds_read_b128 v[132:135], v31 offset:14144
    v_exp_f32 v52, v52
    v_exp_f32 v53, v53
    v_cvt_pk_bf16_f32 v72, v48, v49
    v_exp_f32 v54, v54
    v_exp_f32 v55, v55
    v_cvt_pk_bf16_f32 v73, v50, v51
    v_mfma_f32_32x32x16_bf16 v[80:95], v[120:123], v[64:67], v[80:95]
    v_exp_f32 v56, v56
    v_exp_f32 v57, v57
    v_cvt_pk_bf16_f32 v74, v52, v53
    v_exp_f32 v58, v58
    v_exp_f32 v59, v59
    v_cvt_pk_bf16_f32 v75, v54, v55
    v_mfma_f32_32x32x16_bf16 v[80:95], v[124:127], v[68:71], v[80:95]
    v_exp_f32 v60, v60
    v_exp_f32 v61, v61
    v_cvt_pk_bf16_f32 v76, v56, v57
    v_exp_f32 v62, v62
    v_exp_f32 v63, v63
    v_cvt_pk_bf16_f32 v77, v58, v59
    v_cvt_pk_bf16_f32 v78, v60, v61
    v_cvt_pk_bf16_f32 v79, v62, v63
    v_mfma_f32_32x32x16_bf16 v[48:63], v[112:115], v[16:19], 0
    ds_read_b128 v[112:115], v27 offset:16128
    v_exp_f32 v32, v32
    v_exp_f32 v33, v33
    v_exp_f32 v34, v34
    v_exp_f32 v35, v35
    v_mfma_f32_32x32x8bf16_1k v[48:63], v[116:117], v[20:21], v[48:63]
    ds_read_b64 v[116:117], v29 offset:16128
    v_exp_f32 v36, v36
    v_exp_f32 v37, v37
    v_cvt_pk_bf16_f32 v64, v32, v33
    v_exp_f32 v38, v38
    v_exp_f32 v39, v39
    v_cvt_pk_bf16_f32 v65, v34, v35
    v_mfma_f32_32x32x16_bf16 v[96:111], v[120:123], v[72:75], v[96:111]
    v_exp_f32 v40, v40
    v_exp_f32 v41, v41
    v_cvt_pk_bf16_f32 v66, v36, v37
    v_exp_f32 v42, v42
    v_exp_f32 v43, v43
    v_cvt_pk_bf16_f32 v67, v38, v39
    v_mfma_f32_32x32x16_bf16 v[96:111], v[124:127], v[76:79], v[96:111]
    v_exp_f32 v44, v44
    v_exp_f32 v45, v45
    v_cvt_pk_bf16_f32 v68, v40, v41
    v_exp_f32 v46, v46
    v_exp_f32 v47, v47
    v_cvt_pk_bf16_f32 v69, v42, v43
    v_cvt_pk_bf16_f32 v70, v44, v45
    v_cvt_pk_bf16_f32 v71, v46, v47
    s_waitcnt lgkmcnt(0)
    v_mfma_f32_32x32x16_bf16 v[32:47], v[112:115], v[10:13], 0
    ds_read_b128 v[120:123], v31 offset:16128
    v_exp_f32 v48, v48
    v_exp_f32 v49, v49
    v_exp_f32 v50, v50
    v_exp_f32 v51, v51
    v_mfma_f32_32x32x8bf16_1k v[32:47], v[116:117], v[14:15], v[32:47]
    ds_read_b128 v[124:127], v31 offset:16832
    v_exp_f32 v52, v52
    v_exp_f32 v53, v53
    v_cvt_pk_bf16_f32 v72, v48, v49
    v_exp_f32 v54, v54
    v_exp_f32 v55, v55
    v_cvt_pk_bf16_f32 v73, v50, v51
    v_mfma_f32_32x32x16_bf16 v[80:95], v[128:131], v[64:67], v[80:95]
    v_exp_f32 v56, v56
    v_exp_f32 v57, v57
    v_cvt_pk_bf16_f32 v74, v52, v53
    v_exp_f32 v58, v58
    v_exp_f32 v59, v59
    v_cvt_pk_bf16_f32 v75, v54, v55
    v_mfma_f32_32x32x16_bf16 v[80:95], v[132:135], v[68:71], v[80:95]
    v_exp_f32 v60, v60
    v_exp_f32 v61, v61
    v_cvt_pk_bf16_f32 v76, v56, v57
    v_exp_f32 v62, v62
    v_exp_f32 v63, v63
    v_cvt_pk_bf16_f32 v77, v58, v59
    v_cvt_pk_bf16_f32 v78, v60, v61
    v_cvt_pk_bf16_f32 v79, v62, v63
    v_mfma_f32_32x32x16_bf16 v[48:63], v[112:115], v[16:19], 0
    ds_read_b128 v[112:115], v27 offset:18816
    v_exp_f32 v32, v32
    v_exp_f32 v33, v33
    v_exp_f32 v34, v34
    v_exp_f32 v35, v35
    v_mfma_f32_32x32x8bf16_1k v[48:63], v[116:117], v[20:21], v[48:63]
    ds_read_b64 v[116:117], v29 offset:18816
    v_exp_f32 v36, v36
    v_exp_f32 v37, v37
    v_cvt_pk_bf16_f32 v64, v32, v33
    v_exp_f32 v38, v38
    v_exp_f32 v39, v39
    v_cvt_pk_bf16_f32 v65, v34, v35
    v_mfma_f32_32x32x16_bf16 v[96:111], v[128:131], v[72:75], v[96:111]
    v_exp_f32 v40, v40
    v_exp_f32 v41, v41
    v_cvt_pk_bf16_f32 v66, v36, v37
    v_exp_f32 v42, v42
    v_exp_f32 v43, v43
    v_cvt_pk_bf16_f32 v67, v38, v39
    v_mfma_f32_32x32x16_bf16 v[96:111], v[132:135], v[76:79], v[96:111]
    v_exp_f32 v44, v44
    v_exp_f32 v45, v45
    v_cvt_pk_bf16_f32 v68, v40, v41
    v_exp_f32 v46, v46
    v_exp_f32 v47, v47
    v_cvt_pk_bf16_f32 v69, v42, v43
    v_cvt_pk_bf16_f32 v70, v44, v45
    v_cvt_pk_bf16_f32 v71, v46, v47
    s_waitcnt lgkmcnt(0)
    v_mfma_f32_32x32x16_bf16 v[32:47], v[112:115], v[10:13], 0
    ds_read_b128 v[128:131], v31 offset:18816
    v_exp_f32 v48, v48
    v_exp_f32 v49, v49
    v_exp_f32 v50, v50
    v_exp_f32 v51, v51
    v_mfma_f32_32x32x8bf16_1k v[32:47], v[116:117], v[14:15], v[32:47]
    ds_read_b128 v[132:135], v31 offset:19520
    v_exp_f32 v52, v52
    v_exp_f32 v53, v53
    v_cvt_pk_bf16_f32 v72, v48, v49
    v_exp_f32 v54, v54
    v_exp_f32 v55, v55
    v_cvt_pk_bf16_f32 v73, v50, v51
    v_mfma_f32_32x32x16_bf16 v[80:95], v[120:123], v[64:67], v[80:95]
    v_exp_f32 v56, v56
    v_exp_f32 v57, v57
    v_cvt_pk_bf16_f32 v74, v52, v53
    v_exp_f32 v58, v58
    v_exp_f32 v59, v59
    v_cvt_pk_bf16_f32 v75, v54, v55
    v_mfma_f32_32x32x16_bf16 v[80:95], v[124:127], v[68:71], v[80:95]
    v_exp_f32 v60, v60
    v_exp_f32 v61, v61
    v_cvt_pk_bf16_f32 v76, v56, v57
    v_exp_f32 v62, v62
    v_exp_f32 v63, v63
    v_cvt_pk_bf16_f32 v77, v58, v59
    v_cvt_pk_bf16_f32 v78, v60, v61
    v_cvt_pk_bf16_f32 v79, v62, v63
    v_mfma_f32_32x32x16_bf16 v[48:63], v[112:115], v[16:19], 0
    v_exp_f32 v32, v32
    v_exp_f32 v33, v33
    v_exp_f32 v34, v34
    v_exp_f32 v35, v35
    v_mfma_f32_32x32x8bf16_1k v[48:63], v[116:117], v[20:21], v[48:63]
    v_exp_f32 v36, v36
    v_exp_f32 v37, v37
    v_cvt_pk_bf16_f32 v64, v32, v33
    v_exp_f32 v38, v38
    v_exp_f32 v39, v39
    v_cvt_pk_bf16_f32 v65, v34, v35
    v_mfma_f32_32x32x16_bf16 v[96:111], v[120:123], v[72:75], v[96:111]
    v_exp_f32 v40, v40
    v_exp_f32 v41, v41
    v_cvt_pk_bf16_f32 v66, v36, v37
    v_exp_f32 v42, v42
    v_exp_f32 v43, v43
    v_cvt_pk_bf16_f32 v67, v38, v39
    v_mfma_f32_32x32x16_bf16 v[96:111], v[124:127], v[76:79], v[96:111]
    v_exp_f32 v44, v44
    v_exp_f32 v45, v45
    v_cvt_pk_bf16_f32 v68, v40, v41
    v_exp_f32 v46, v46
    v_exp_f32 v47, v47
    v_cvt_pk_bf16_f32 v69, v42, v43
    v_cvt_pk_bf16_f32 v70, v44, v45
    v_cvt_pk_bf16_f32 v71, v46, v47
    s_waitcnt lgkmcnt(0)
    v_exp_f32 v48, v48
    v_exp_f32 v49, v49
    v_exp_f32 v50, v50
    v_exp_f32 v51, v51
    v_exp_f32 v52, v52
    v_exp_f32 v53, v53
    v_cvt_pk_bf16_f32 v72, v48, v49
    v_exp_f32 v54, v54
    v_exp_f32 v55, v55
    v_cvt_pk_bf16_f32 v73, v50, v51
    v_mfma_f32_32x32x16_bf16 v[80:95], v[128:131], v[64:67], v[80:95]
    v_exp_f32 v56, v56
    v_exp_f32 v57, v57
    v_cvt_pk_bf16_f32 v74, v52, v53
    v_exp_f32 v58, v58
    v_exp_f32 v59, v59
    v_cvt_pk_bf16_f32 v75, v54, v55
    v_mfma_f32_32x32x16_bf16 v[80:95], v[132:135], v[68:71], v[80:95]
    v_exp_f32 v60, v60
    v_exp_f32 v61, v61
    v_cvt_pk_bf16_f32 v76, v56, v57
    v_exp_f32 v62, v62
    v_exp_f32 v63, v63
    v_cvt_pk_bf16_f32 v77, v58, v59
    v_cvt_pk_bf16_f32 v78, v60, v61
    v_cvt_pk_bf16_f32 v79, v62, v63
    s_nop 1
    v_mfma_f32_32x32x16_bf16 v[96:111], v[128:131], v[72:75], v[96:111]
    v_mfma_f32_32x32x16_bf16 v[96:111], v[132:135], v[76:79], v[96:111]
L_tail:
    s_cmp_eq_u32 s70, 0
    s_cbranch_scc0 L_ex_b
    s_mul_i32 s76, s70, 20480
    s_add_u32 s76, s76, 81920
    s_mul_i32 s77, s70, 30720
    s_add_u32 s77, s77, 43008
    s_mul_i32 s78, s70, 76800
    s_add_u32 s78, s78, 48128
    v_lshrrev_b32 v2, 5, v0
    v_lshlrev_b32 v2, 4, v2
    v_bfe_u32 v3, v0, 4, 1
    v_lshlrev_b32 v3, 2, v3
    v_bfe_u32 v4, v0, 2, 2
    v_add3_u32 v2, v2, v3, v4
    v_mul_u32_u24 v2, 160, v2
    v_and_b32 v3, 3, v0
    v_lshlrev_b32 v3, 3, v3
    v_add3_u32 v156, v2, v3, s76
    v_add3_u32 v157, v2, v3, s77
    v_add3_u32 v158, v2, v3, s78
    s_mul_i32 s76, s71, 81920
    s_mul_i32 s77, s69, 20480
    s_add_u32 s76, s76, s77
    s_mul_i32 s77, s70, 10240
    s_add_u32 s76, s76, s77
    s_add_u32 s76, s76, 3145728
    v_add_u32 v159, s76, v1
    s_lshl_b32 s76, s69, 4
    v_and_b32 v2, 15, v0
    v_add_u32 v2, s76, v2
    v_mul_u32_u24 v2, 160, v2
    v_lshrrev_b32 v3, 4, v0
    v_lshlrev_b32 v3, 3, v3
    v_add_u32 v2, v2, v3
    v_add_u32 v160, 24576, v2
    s_mul_i32 s76, s68, 960
    s_add_u32 s76, s76, 24576
    v_add_u32 v161, s76, v1
    v_mul_u32_u24 v2, 0x199a, v0
    v_lshrrev_b32 v2, 16, v2
    v_mul_u32_u24 v3, 10, v2
    v_sub_u32 v3, v0, v3
    v_lshlrev_b32 v3, 4, v3
    v_mul_u32_u24 v2, 2560, v2
    v_add_u32 v162, v2, v3
    v_lshrrev_b32 v2, 2, v0
    v_and_b32 v2, 3, v2
    s_lshl_b32 s76, s70, 2
    v_add_u32 v2, s76, v2
    v_lshlrev_b32 v2, 3, v2
    v_and_b32 v3, 1, v0
    v_bfe_u32 v4, v0, 1, 1
    v_lshlrev_b32 v4, 2, v4
    v_add3_u32 v2, v2, v3, v4
    s_and_b32 s76, s69, 2
    v_add_u32 v2, s76, v2
    v_lshlrev_b32 v163, 2, v2
    s_mul_i32 s76, s68, 3072
    s_add_u32 s76, s76, 0
    v_add_u32 v164, s76, v1
    s_xor_b32 s77, s68, 4
    s_mul_i32 s77, s77, 3072
    s_add_u32 s77, s77, 0
    v_add_u32 v165, s77, v1
    s_nop 2
    s_barrier
    ds_write_b128 v164, v[96:99] offset:0
    ds_write_b128 v164, v[100:103] offset:1024
    ds_write_b128 v164, v[104:107] offset:2048
    s_waitcnt lgkmcnt(0)
    s_barrier
    ds_read_b128 v[40:43], v165 offset:2048
    ds_read_b128 v[32:35], v165 offset:0
    ds_read_b128 v[36:39], v165 offset:1024
    s_waitcnt lgkmcnt(2)
    v_add_f32 v88, v88, v40
    v_add_f32 v89, v89, v41
    v_mov_b32 v4, v88
    v_mov_b32 v5, v88
    v_add_f32 v90, v90, v42
    v_add_f32 v91, v91, v43
    v_permlane32_swap_b32 v4, v5
    s_waitcnt lgkmcnt(0)
    v_add_f32 v80, v80, v32
    v_rcp_f32 v5, v5
    v_add_f32 v81, v81, v33
    v_add_f32 v82, v82, v34
    v_add_f32 v83, v83, v35
    v_add_f32 v84, v84, v36
    v_add_f32 v85, v85, v37
    v_add_f32 v86, v86, v38
    v_add_f32 v87, v87, v39
    v_mul_f32 v80, v80, v5
    v_mul_f32 v81, v81, v5
    v_mul_f32 v82, v82, v5
    v_mul_f32 v83, v83, v5
    v_mul_f32 v84, v84, v5
    v_mul_f32 v85, v85, v5
    v_mul_f32 v86, v86, v5
    v_mul_f32 v87, v87, v5
    v_mul_f32 v88, v88, v5
    v_mul_f32 v89, v89, v5
    v_mul_f32 v90, v90, v5
    v_mul_f32 v91, v91, v5
    v_cvt_pk_bf16_f32 v32, v80, v81
    v_cvt_pk_bf16_f32 v33, v82, v83
    v_cvt_pk_bf16_f32 v34, v84, v85
    v_cvt_pk_bf16_f32 v35, v86, v87
    v_cvt_pk_bf16_f32 v36, v88, v89
    v_cvt_pk_bf16_f32 v37, v90, v91
    s_branch L_ex_j
L_ex_b:
    s_nop 6
    s_nop 2
    s_barrier
    ds_write_b128 v164, v[80:83] offset:0
    ds_write_b128 v164, v[84:87] offset:1024
    ds_write_b128 v164, v[88:91] offset:2048
    s_waitcnt lgkmcnt(0)
    s_barrier
    ds_read_b128 v[40:43], v165 offset:2048
    ds_read_b128 v[32:35], v165 offset:0
    ds_read_b128 v[36:39], v165 offset:1024
    s_waitcnt lgkmcnt(2)
    v_add_f32 v104, v104, v40
    v_add_f32 v105, v105, v41
    v_mov_b32 v4, v104
    v_mov_b32 v5, v104
    v_add_f32 v106, v106, v42
    v_add_f32 v107, v107, v43
    v_permlane32_swap_b32 v4, v5
    s_waitcnt lgkmcnt(0)
    v_add_f32 v96, v96, v32
    v_rcp_f32 v5, v5
    v_add_f32 v97, v97, v33
    v_add_f32 v98, v98, v34
    v_add_f32 v99, v99, v35
    v_add_f32 v100, v100, v36
    v_add_f32 v101, v101, v37
    v_add_f32 v102, v102, v38
    v_add_f32 v103, v103, v39
    v_mul_f32 v96, v96, v5
    v_mul_f32 v97, v97, v5
    v_mul_f32 v98, v98, v5
    v_mul_f32 v99, v99, v5
    v_mul_f32 v100, v100, v5
    v_mul_f32 v101, v101, v5
    v_mul_f32 v102, v102, v5
    v_mul_f32 v103, v103, v5
    v_mul_f32 v104, v104, v5
    v_mul_f32 v105, v105, v5
    v_mul_f32 v106, v106, v5
    v_mul_f32 v107, v107, v5
    v_cvt_pk_bf16_f32 v32, v96, v97
    v_cvt_pk_bf16_f32 v33, v98, v99
    v_cvt_pk_bf16_f32 v34, v100, v101
    v_cvt_pk_bf16_f32 v35, v102, v103
    v_cvt_pk_bf16_f32 v36, v104, v105
    v_cvt_pk_bf16_f32 v37, v106, v107
L_ex_j:
    s_cmp_eq_u32 s101, 0
    s_cbranch_scc1 L_ost_far
    buffer_store_dwordx2 v[32:33], v23, s[56:59], 0 offen
    buffer_store_dwordx2 v[34:35], v24, s[56:59], 0 offen
    buffer_store_dwordx2 v[36:37], v25, s[56:59], 0 offen
    s_branch L_ost_j
L_ost_far:
    buffer_store_dwordx2 v[32:33], v23, s[56:59], 0 offen sc1
    buffer_store_dwordx2 v[34:35], v24, s[56:59], 0 offen sc1
    buffer_store_dwordx2 v[36:37], v25, s[56:59], 0 offen sc1
L_ost_j:
    ds_read_b64_tr_b16 v[56:57], v156 offset:0
    ds_read_b64_tr_b16 v[58:59], v156 offset:1280
    ds_read_b64_tr_b16 v[60:61], v156 offset:32
    ds_read_b64_tr_b16 v[62:63], v156 offset:1312
    ds_read_b64_tr_b16 v[64:65], v156 offset:64
    ds_read_b64_tr_b16 v[66:67], v156 offset:1344
    ds_read_b64_tr_b16 v[68:69], v156 offset:96
    ds_read_b64_tr_b16 v[70:71], v156 offset:1376
    ds_read_b64_tr_b16 v[72:73], v156 offset:128
    ds_read_b64_tr_b16 v[74:75], v156 offset:1408
    ds_read_b64_tr_b16 v[76:77], v156 offset:5120
    ds_read_b64_tr_b16 v[78:79], v156 offset:6400
    ds_read_b64_tr_b16 v[80:81], v156 offset:5152
    ds_read_b64_tr_b16 v[82:83], v156 offset:6432
    ds_read_b64_tr_b16 v[84:85], v156 offset:5184
    ds_read_b64_tr_b16 v[86:87], v156 offset:6464
    ds_read_b64_tr_b16 v[88:89], v156 offset:5216
    ds_read_b64_tr_b16 v[90:91], v156 offset:6496
    ds_read_b64_tr_b16 v[92:93], v156 offset:5248
    ds_read_b64_tr_b16 v[94:95], v156 offset:6528
    ds_read_b64_tr_b16 v[96:97], v156 offset:10240
    ds_read_b64_tr_b16 v[98:99], v156 offset:11520
    ds_read_b64_tr_b16 v[100:101], v156 offset:10272
    ds_read_b64_tr_b16 v[102:103], v156 offset:11552
    ds_read_b64_tr_b16 v[104:105], v156 offset:10304
    ds_read_b64_tr_b16 v[106:107], v156 offset:11584
    ds_read_b64_tr_b16 v[108:109], v156 offset:10336
    ds_read_b64_tr_b16 v[110:111], v156 offset:11616
    ds_read_b64_tr_b16 v[112:113], v156 offset:10368
    ds_read_b64_tr_b16 v[114:115], v156 offset:11648
    ds_read_b64_tr_b16 v[116:117], v156 offset:15360
    ds_read_b64_tr_b16 v[118:119], v156 offset:16640
    ds_read_b64_tr_b16 v[120:121], v156 offset:15392
    ds_read_b64_tr_b16 v[122:123], v156 offset:16672
    ds_read_b64_tr_b16 v[124:125], v156 offset:15424
    ds_read_b64_tr_b16 v[126:127], v156 offset:16704
    ds_read_b64_tr_b16 v[128:129], v156 offset:15456
    ds_read_b64_tr_b16 v[130:131], v156 offset:16736
    ds_read_b64_tr_b16 v[132:133], v156 offset:15488
    ds_read_b64_tr_b16 v[134:135], v156 offset:16768
    s_lshl_b32 s76, s71, 8
    s_add_u32 s76, s76, 245760
    s_lshl_b32 s77, s72, 3
    s_add_u32 s77, s77, s68
    s_lshl_b32 s77, s77, 2
    s_add_u32 s77, s77, s76
    v_mov_b32 v2, 0
    v_mov_b32 v3, s3
    s_waitcnt vmcnt(0)
    s_mov_b64 exec, 1
    s_cmp_eq_u32 s101, 0
    s_cbranch_scc1 L_ofl_far
    buffer_store_dword v3, v2, s[56:59], s77 offen
    s_branch L_ofl_j
L_ofl_far:
    buffer_store_dword v3, v2, s[56:59], s77 offen sc1
L_ofl_j:
    s_mov_b64 exec, -1
    s_mov_b32 s97, 0
    s_mov_b32 exec_hi, 0
    s_mov_b32 exec_lo, 0xffff
L_poll2:
    buffer_load_dword v3, v163, s[56:59], s76 offen sc1
    s_add_u32 s97, s97, 1
    s_cmp_gt_u32 s97, 0x40000
    s_cbranch_scc1 L_poll2_done
    s_waitcnt vmcnt(0)
    v_cmp_ne_u32 vcc, s3, v3
    s_cbranch_vccz L_poll2_done
    s_sleep 1
    s_branch L_poll2
L_poll2_done:
    s_mov_b64 exec, -1
    buffer_load_dwordx4 v[16:19], v159, s[56:59], 0 offen offset:0 sc1
    buffer_load_dwordx4 v[20:23], v159, s[56:59], 0 offen offset:1024 sc1
    buffer_load_dwordx4 v[24:27], v159, s[56:59], 0 offen offset:2048 sc1
    buffer_load_dwordx4 v[28:31], v159, s[56:59], 0 offen offset:3072 sc1
    v_add_u32 v159, 4096, v159
    buffer_load_dwordx4 v[32:35], v159, s[56:59], 0 offen offset:0 sc1
    buffer_load_dwordx4 v[36:39], v159, s[56:59], 0 offen offset:1024 sc1
    buffer_load_dwordx4 v[40:43], v159, s[56:59], 0 offen offset:2048 sc1
    buffer_load_dwordx4 v[44:47], v159, s[56:59], 0 offen offset:3072 sc1
    v_add_u32 v159, 4096, v159
    buffer_load_dwordx4 v[48:51], v159, s[56:59], 0 offen offset:0 sc1
    buffer_load_dwordx4 v[52:55], v159, s[56:59], 0 offen offset:1024 sc1
    s_waitcnt vmcnt(9) lgkmcnt(0)
    v_mfma_f32_16x16x32_bf16 v[136:139], v[56:59], v[16:19], 0
    v_mfma_f32_16x16x32_bf16 v[140:143], v[60:63], v[16:19], 0
    v_mfma_f32_16x16x32_bf16 v[144:147], v[64:67], v[16:19], 0
    v_mfma_f32_16x16x32_bf16 v[148:151], v[68:71], v[16:19], 0
    v_mfma_f32_16x16x32_bf16 v[152:155], v[72:75], v[16:19], 0
    ds_read_b64_tr_b16 v[56:57], v157 offset:0
    ds_read_b64_tr_b16 v[58:59], v157 offset:1280
    ds_read_b64_tr_b16 v[60:61], v157 offset:32
    ds_read_b64_tr_b16 v[62:63], v157 offset:1312
    ds_read_b64_tr_b16 v[64:65], v157 offset:64
    ds_read_b64_tr_b16 v[66:67], v157 offset:1344
    ds_read_b64_tr_b16 v[68:69], v157 offset:96
    ds_read_b64_tr_b16 v[70:71], v157 offset:1376
    ds_read_b64_tr_b16 v[72:73], v157 offset:128
    ds_read_b64_tr_b16 v[74:75], v157 offset:1408
    s_waitcnt vmcnt(8)
    v_mfma_f32_16x16x32_bf16 v[136:139], v[76:79], v[20:23], v[136:139]
    v_mfma_f32_16x16x32_bf16 v[140:143], v[80:83], v[20:23], v[140:143]
    v_mfma_f32_16x16x32_bf16 v[144:147], v[84:87], v[20:23], v[144:147]
    v_mfma_f32_16x16x32_bf16 v[148:151], v[88:91], v[20:23], v[148:151]
    v_mfma_f32_16x16x32_bf16 v[152:155], v[92:95], v[20:23], v[152:155]
    ds_read_b64_tr_b16 v[76:77], v158 offset:0
    ds_read_b64_tr_b16 v[78:79], v158 offset:1280
    ds_read_b64_tr_b16 v[80:81], v158 offset:32
    ds_read_b64_tr_b16 v[82:83], v158 offset:1312
    ds_read_b64_tr_b16 v[84:85], v158 offset:64
    ds_read_b64_tr_b16 v[86:87], v158 offset:1344
    ds_read_b64_tr_b16 v[88:89], v158 offset:96
    ds_read_b64_tr_b16 v[90:91], v158 offset:1376
    ds_read_b64_tr_b16 v[92:93], v158 offset:128
    ds_read_b64_tr_b16 v[94:95], v158 offset:1408
    s_waitcnt vmcnt(7)
    v_mfma_f32_16x16x32_bf16 v[136:139], v[96:99], v[24:27], v[136:139]
    v_mfma_f32_16x16x32_bf16 v[140:143], v[100:103], v[24:27], v[140:143]
    v_mfma_f32_16x16x32_bf16 v[144:147], v[104:107], v[24:27], v[144:147]
    v_mfma_f32_16x16x32_bf16 v[148:151], v[108:111], v[24:27], v[148:151]
    v_mfma_f32_16x16x32_bf16 v[152:155], v[112:115], v[24:27], v[152:155]
    ds_read_b64_tr_b16 v[96:97], v158 offset:5120
    ds_read_b64_tr_b16 v[98:99], v158 offset:6400
    ds_read_b64_tr_b16 v[100:101], v158 offset:5152
    ds_read_b64_tr_b16 v[102:103], v158 offset:6432
    ds_read_b64_tr_b16 v[104:105], v158 offset:5184
    ds_read_b64_tr_b16 v[106:107], v158 offset:6464
    ds_read_b64_tr_b16 v[108:109], v158 offset:5216
    ds_read_b64_tr_b16 v[110:111], v158 offset:6496
    ds_read_b64_tr_b16 v[112:113], v158 offset:5248
    ds_read_b64_tr_b16 v[114:115], v158 offset:6528
    s_waitcnt vmcnt(6)
    v_mfma_f32_16x16x32_bf16 v[136:139], v[116:119], v[28:31], v[136:139]
    v_mfma_f32_16x16x32_bf16 v[140:143], v[120:123], v[28:31], v[140:143]
    v_mfma_f32_16x16x32_bf16 v[144:147], v[124:127], v[28:31], v[144:147]
    v_mfma_f32_16x16x32_bf16 v[148:151], v[128:131], v[28:31], v[148:151]
    v_mfma_f32_16x16x32_bf16 v[152:155], v[132:135], v[28:31], v[152:155]
    ds_read_b64_tr_b16 v[116:117], v158 offset:10240
    ds_read_b64_tr_b16 v[118:119], v158 offset:11520
    ds_read_b64_tr_b16 v[120:121], v158 offset:10272
    ds_read_b64_tr_b16 v[122:123], v158 offset:11552
    ds_read_b64_tr_b16 v[124:125], v158 offset:10304
    ds_read_b64_tr_b16 v[126:127], v158 offset:11584
    ds_read_b64_tr_b16 v[128:129], v158 offset:10336
    ds_read_b64_tr_b16 v[130:131], v158 offset:11616
    ds_read_b64_tr_b16 v[132:133], v158 offset:10368
    ds_read_b64_tr_b16 v[134:135], v158 offset:11648
    s_waitcnt vmcnt(5) lgkmcnt(15)
    v_mfma_f32_16x16x32_bf16 v[136:139], v[56:59], v[32:35], v[136:139]
    v_mfma_f32_16x16x32_bf16 v[140:143], v[60:63], v[32:35], v[140:143]
    v_mfma_f32_16x16x32_bf16 v[144:147], v[64:67], v[32:35], v[144:147]
    v_mfma_f32_16x16x32_bf16 v[148:151], v[68:71], v[32:35], v[148:151]
    v_mfma_f32_16x16x32_bf16 v[152:155], v[72:75], v[32:35], v[152:155]
    ds_read_b64_tr_b16 v[56:57], v158 offset:15360
    ds_read_b64_tr_b16 v[58:59], v158 offset:16640
    ds_read_b64_tr_b16 v[60:61], v158 offset:15392
    ds_read_b64_tr_b16 v[62:63], v158 offset:16672
    ds_read_b64_tr_b16 v[64:65], v158 offset:15424
    ds_read_b64_tr_b16 v[66:67], v158 offset:16704
    ds_read_b64_tr_b16 v[68:69], v158 offset:15456
    ds_read_b64_tr_b16 v[70:71], v158 offset:16736
    ds_read_b64_tr_b16 v[72:73], v158 offset:15488
    ds_read_b64_tr_b16 v[74:75], v158 offset:16768
    s_waitcnt vmcnt(4) lgkmcnt(15)
    v_mfma_f32_16x16x32_bf16 v[136:139], v[76:79], v[36:39], v[136:139]
    v_mfma_f32_16x16x32_bf16 v[140:143], v[80:83], v[36:39], v[140:143]
    v_mfma_f32_16x16x32_bf16 v[144:147], v[84:87], v[36:39], v[144:147]
    v_mfma_f32_16x16x32_bf16 v[148:151], v[88:91], v[36:39], v[148:151]
    v_mfma_f32_16x16x32_bf16 v[152:155], v[92:95], v[36:39], v[152:155]
    ds_read_b64_tr_b16 v[76:77], v158 offset:20480
    ds_read_b64_tr_b16 v[78:79], v158 offset:21760
    ds_read_b64_tr_b16 v[80:81], v158 offset:20512
    ds_read_b64_tr_b16 v[82:83], v158 offset:21792
    ds_read_b64_tr_b16 v[84:85], v158 offset:20544
    ds_read_b64_tr_b16 v[86:87], v158 offset:21824
    ds_read_b64_tr_b16 v[88:89], v158 offset:20576
    ds_read_b64_tr_b16 v[90:91], v158 offset:21856
    ds_read_b64_tr_b16 v[92:93], v158 offset:20608
    ds_read_b64_tr_b16 v[94:95], v158 offset:21888
    s_waitcnt vmcnt(3) lgkmcnt(15)
    v_mfma_f32_16x16x32_bf16 v[136:139], v[96:99], v[40:43], v[136:139]
    v_mfma_f32_16x16x32_bf16 v[140:143], v[100:103], v[40:43], v[140:143]
    v_mfma_f32_16x16x32_bf16 v[144:147], v[104:107], v[40:43], v[144:147]
    v_mfma_f32_16x16x32_bf16 v[148:151], v[108:111], v[40:43], v[148:151]
    v_mfma_f32_16x16x32_bf16 v[152:155], v[112:115], v[40:43], v[152:155]
    s_waitcnt vmcnt(2) lgkmcnt(15)
    v_mfma_f32_16x16x32_bf16 v[136:139], v[116:119], v[44:47], v[136:139]
    v_mfma_f32_16x16x32_bf16 v[140:143], v[120:123], v[44:47], v[140:143]
    v_mfma_f32_16x16x32_bf16 v[144:147], v[124:127], v[44:47], v[144:147]
    v_mfma_f32_16x16x32_bf16 v[148:151], v[128:131], v[44:47], v[148:151]
    v_mfma_f32_16x16x32_bf16 v[152:155], v[132:135], v[44:47], v[152:155]
    s_waitcnt vmcnt(1) lgkmcnt(10)
    v_mfma_f32_16x16x32_bf16 v[136:139], v[56:59], v[48:51], v[136:139]
    v_mfma_f32_16x16x32_bf16 v[140:143], v[60:63], v[48:51], v[140:143]
    v_mfma_f32_16x16x32_bf16 v[144:147], v[64:67], v[48:51], v[144:147]
    v_mfma_f32_16x16x32_bf16 v[148:151], v[68:71], v[48:51], v[148:151]
    v_mfma_f32_16x16x32_bf16 v[152:155], v[72:75], v[48:51], v[152:155]
    s_waitcnt vmcnt(0) lgkmcnt(0)
    v_mfma_f32_16x16x32_bf16 v[136:139], v[76:79], v[52:55], v[136:139]
    v_mfma_f32_16x16x32_bf16 v[140:143], v[80:83], v[52:55], v[140:143]
    v_mfma_f32_16x16x32_bf16 v[144:147], v[84:87], v[52:55], v[144:147]
    v_mfma_f32_16x16x32_bf16 v[148:151], v[88:91], v[52:55], v[148:151]
    v_mfma_f32_16x16x32_bf16 v[152:155], v[92:95], v[52:55], v[152:155]
    s_cmp_eq_u32 s70, 0
    s_cbranch_scc0 L_red_b
    s_nop 7
    ds_write_b128 v165, v[148:151] offset:0
    ds_write_b128 v165, v[152:155] offset:1024
    s_waitcnt lgkmcnt(0)
    s_barrier
    ds_read_b128 v[16:19], v164 offset:0
    ds_read_b128 v[20:23], v164 offset:1024
    ds_read_b128 v[24:27], v164 offset:2048
    s_waitcnt lgkmcnt(2)
    v_add_f32 v136, v136, v16
    v_add_f32 v137, v137, v17
    v_add_f32 v138, v138, v18
    v_add_f32 v139, v139, v19
    v_cvt_pk_bf16_f32 v32, v136, v137
    v_cvt_pk_bf16_f32 v33, v138, v139
    ds_write_b64 v160, v[32:33] offset:0
    s_waitcnt lgkmcnt(2)
    v_add_f32 v140, v140, v20
    v_add_f32 v141, v141, v21
    v_add_f32 v142, v142, v22
    v_add_f32 v143, v143, v23
    v_cvt_pk_bf16_f32 v34, v140, v141
    v_cvt_pk_bf16_f32 v35, v142, v143
    ds_write_b64 v160, v[34:35] offset:32
    s_waitcnt lgkmcnt(2)
    v_add_f32 v144, v144, v24
    v_add_f32 v145, v145, v25
    v_add_f32 v146, v146, v26
    v_add_f32 v147, v147, v27
    v_cvt_pk_bf16_f32 v36, v144, v145
    v_cvt_pk_bf16_f32 v37, v146, v147
    ds_write_b64 v160, v[36:37] offset:64
    s_branch L_red_j
L_red_b:
    s_nop 7
    ds_write_b128 v165, v[136:139] offset:0
    ds_write_b128 v165, v[140:143] offset:1024
    ds_write_b128 v165, v[144:147] offset:2048
    s_waitcnt lgkmcnt(0)
    s_barrier
    ds_read_b128 v[16:19], v164 offset:0
    ds_read_b128 v[20:23], v164 offset:1024
    s_waitcnt lgkmcnt(1)
    v_add_f32 v148, v148, v16
    v_add_f32 v149, v149, v17
    v_add_f32 v150, v150, v18
    v_add_f32 v151, v151, v19
    v_cvt_pk_bf16_f32 v32, v148, v149
    v_cvt_pk_bf16_f32 v33, v150, v151
    ds_write_b64 v160, v[32:33] offset:96
    s_waitcnt lgkmcnt(1)
    v_add_f32 v152, v152, v20
    v_add_f32 v153, v153, v21
    v_add_f32 v154, v154, v22
    v_add_f32 v155, v155, v23
    v_cvt_pk_bf16_f32 v34, v152, v153
    v_cvt_pk_bf16_f32 v35, v154, v155
    ds_write_b64 v160, v[34:35] offset:128
L_red_j:
    s_lshl_b32 s76, s71, 6
    s_mul_i32 s77, s68, 6
    s_add_u32 s76, s76, s77
    s_mul_i32 s76, s76, 2560
    s_mul_i32 s77, s72, 160
    s_add_u32 s76, s76, s77
    s_add_u32 s77, s76, 122880
    s_waitcnt lgkmcnt(0)
    s_barrier
    ds_read_b128 v[16:19], v161
    ds_read_b128 v[20:23], v161 offset:7680
    s_mov_b32 exec_hi, 0x0fffffff
    s_waitcnt lgkmcnt(1)
    buffer_store_dwordx4 v[16:19], v162, s[60:63], s76 offen
    s_cmp_ge_u32 s68, 3
    s_cbranch_scc1 L_exit
    s_cmp_eq_u32 s68, 2
    s_cselect_b32 exec_hi, 0xff, exec_hi
    s_waitcnt lgkmcnt(0)
    buffer_store_dwordx4 v[20:23], v162, s[60:63], s77 offen
L_exit:
    s_endpgm
L_ring0:
    s_mov_b32 s97, 0
L_ring0_sp:
    ds_read_b32 v2, v8 offset:4
    s_add_u32 s97, s97, 1
    s_cmp_gt_u32 s97, 0x1000000
    s_cbranch_scc1 L_ring0_ok
    s_waitcnt lgkmcnt(0)
    v_cmp_eq_u32 vcc, 4, v2
    s_cbranch_vccnz L_ring0_ok
    s_sleep 8
    s_branch L_ring0_sp
L_ring1:
    s_mov_b32 s97, 0
L_ring1_sp:
    ds_read_b32 v2, v8 offset:8
    s_add_u32 s97, s97, 1
    s_cmp_gt_u32 s97, 0x1000000
    s_cbranch_scc1 L_ring1_ok
    s_waitcnt lgkmcnt(0)
    v_cmp_eq_u32 vcc, 4, v2
    s_cbranch_vccnz L_ring1_ok
    s_sleep 8
    s_branch L_ring1_sp
L_ring2:
    s_mov_b32 s97, 0
L_ring2_sp:
    ds_read_b32 v2, v8 offset:12
    s_add_u32 s97, s97, 1
    s_cmp_gt_u32 s97, 0x1000000
    s_cbranch_scc1 L_ring2_ok
    s_waitcnt lgkmcnt(0)
    v_cmp_eq_u32 vcc, 4, v2
    s_cbranch_vccnz L_ring2_ok
    s_sleep 8
    s_branch L_ring2_sp
L_fallback:
    s_waitcnt lgkmcnt(0)
    v_mov_b32 v2, 163440
    v_mov_b32 v3, 1
    s_mov_b64 exec, 1
    ds_add_u32 v2, v3
    s_mov_b64 exec, -1
    v_mov_b32 v2, 163444
    v_mov_b32 v3, 1
    s_mov_b64 exec, 1
    ds_add_u32 v2, v3
    s_mov_b64 exec, -1
    v_mov_b32 v2, 163448
    v_mov_b32 v3, 1
    s_mov_b64 exec, 1
    ds_add_u32 v2, v3
    s_mov_b64 exec, -1
    s_mul_i32 s88, s70, 86016
    s_add_u32 s88, s88, 73728
    v_and_b32 v3, 31, v0
    v_lshlrev_b32 v4, 3, v3
    v_lshrrev_b32 v2, 5, v0
    v_min_u32 v3, 21, v3
    v_mul_u32_u24 v2, 22, v2
    v_add_u32 v3, v3, v2
    v_lshlrev_b32 v5, 4, v3
    v_mov_b32 v6, 0xff800000
    v_mov_b32 v7, 0xff800000
    s_waitcnt lgkmcnt(0)
    s_mov_b32 s84, s88
    s_mov_b32 s96, 32
L_fb1:
    buffer_load_dwordx4 v[112:115], v1, s[56:59], s84 offen sc1
    buffer_load_dwordx2 v[116:117], v4, s[56:59], s84 offen offset:2432 sc1
    s_waitcnt vmcnt(0)
    v_mfma_f32_32x32x16_bf16 v[32:47], v[112:115], v[10:13], 0
    v_mfma_f32_32x32x8bf16_1k v[32:47], v[116:117], v[14:15], v[32:47]
    v_mfma_f32_32x32x16_bf16 v[48:63], v[112:115], v[16:19], 0
    v_mfma_f32_32x32x8bf16_1k v[48:63], v[116:117], v[20:21], v[48:63]
    s_nop 11
    v_max3_f32 v6, v6, v32, v33
    v_max3_f32 v6, v6, v34, v35
    v_max3_f32 v6, v6, v36, v37
    v_max3_f32 v6, v6, v38, v39
    v_max3_f32 v6, v6, v40, v41
    v_max3_f32 v6, v6, v42, v43
    v_max3_f32 v6, v6, v44, v45
    v_max3_f32 v6, v6, v46, v47
    v_max3_f32 v7, v7, v48, v49
    v_max3_f32 v7, v7, v50, v51
    v_max3_f32 v7, v7, v52, v53
    v_max3_f32 v7, v7, v54, v55
    v_max3_f32 v7, v7, v56, v57
    v_max3_f32 v7, v7, v58, v59
    v_max3_f32 v7, v7, v60, v61
    v_max3_f32 v7, v7, v62, v63
    s_add_u32 s84, s84, 2688
    s_sub_u32 s96, s96, 1
    s_cmp_lg_u32 s96, 0
    s_cbranch_scc1 L_fb1
    v_mov_b32 v8, v6
    s_nop 1
    v_permlane32_swap_b32 v6, v8
    s_nop 1
    v_max_f32 v6, v6, v8
    v_mov_b32 v8, v7
    s_nop 1
    v_permlane32_swap_b32 v7, v8
    s_nop 1
    v_max_f32 v7, v7, v8
    s_lshl_b32 s76, s68, 8
    s_add_u32 s77, s76, 78848
    v_add_u32 v3, s77, v4
    ds_write_b64 v3, v[6:7]
    s_xor_b32 s76, s76, 1024
    s_add_u32 s77, s76, 78848
    v_add_u32 v3, s77, v4
    v_mov_b32 v5, v3
    s_waitcnt lgkmcnt(0)
    s_lshl_b32 s76, s69, 2
    s_add_u32 s76, s76, 163472
    v_mov_b32 v2, s76
    v_mov_b32 v3, 1
    s_mov_b64 exec, 1
    ds_add_u32 v2, v3
    s_mov_b64 exec, -1
    s_mov_b32 s97, 0
L_fbx:
    ds_read_b32 v3, v2
    s_add_u32 s97, s97, 1
    s_cmp_gt_u32 s97, 0x1000000
    s_cbranch_scc1 L_fbx_done
    s_waitcnt lgkmcnt(0)
    v_cmp_gt_u32 vcc, 2, v3
    s_cbranch_vccz L_fbx_done
    s_sleep 1
    s_branch L_fbx
L_fbx_done:
    ds_read_b64 v[8:9], v5
    v_and_b32 v3, 31, v0
    v_lshrrev_b32 v2, 5, v0
    v_min_u32 v3, 21, v3
    v_mul_u32_u24 v2, 22, v2
    v_add_u32 v3, v3, v2
    v_lshlrev_b32 v5, 4, v3
    s_waitcnt lgkmcnt(0)
    v_max_f32 v6, v6, v8
    v_max_f32 v7, v7, v9
    v_sub_f32 v136, 0, v6
    v_sub_f32 v152, 0, v7
    v_mov_b32 v80, 0
    v_mov_b32 v96, 0
    v_sub_f32 v137, 0, v6
    v_sub_f32 v153, 0, v7
    v_mov_b32 v81, 0
    v_mov_b32 v97, 0
    v_sub_f32 v138, 0, v6
    v_sub_f32 v154, 0, v7
    v_mov_b32 v82, 0
    v_mov_b32 v98, 0
    v_sub_f32 v139, 0, v6
    v_sub_f32 v155, 0, v7
    v_mov_b32 v83, 0
    v_mov_b32 v99, 0
    v_sub_f32 v140, 0, v6
    v_sub_f32 v156, 0, v7
    v_mov_b32 v84, 0
    v_mov_b32 v100, 0
    v_sub_f32 v141, 0, v6
    v_sub_f32 v157, 0, v7
    v_mov_b32 v85, 0
    v_mov_b32 v101, 0
    v_sub_f32 v142, 0, v6
    v_sub_f32 v158, 0, v7
    v_mov_b32 v86, 0
    v_mov_b32 v102, 0
    v_sub_f32 v143, 0, v6
    v_sub_f32 v159, 0, v7
    v_mov_b32 v87, 0
    v_mov_b32 v103, 0
    v_sub_f32 v144, 0, v6
    v_sub_f32 v160, 0, v7
    v_mov_b32 v88, 0
    v_mov_b32 v104, 0
    v_sub_f32 v145, 0, v6
    v_sub_f32 v161, 0, v7
    v_mov_b32 v89, 0
    v_mov_b32 v105, 0
    v_sub_f32 v146, 0, v6
    v_sub_f32 v162, 0, v7
    v_mov_b32 v90, 0
    v_mov_b32 v106, 0
    v_sub_f32 v147, 0, v6
    v_sub_f32 v163, 0, v7
    v_mov_b32 v91, 0
    v_mov_b32 v107, 0
    v_sub_f32 v148, 0, v6
    v_sub_f32 v164, 0, v7
    v_mov_b32 v92, 0
    v_mov_b32 v108, 0
    v_sub_f32 v149, 0, v6
    v_sub_f32 v165, 0, v7
    v_mov_b32 v93, 0
    v_mov_b32 v109, 0
    v_sub_f32 v150, 0, v6
    v_sub_f32 v166, 0, v7
    v_mov_b32 v94, 0
    v_mov_b32 v110, 0
    v_sub_f32 v151, 0, v6
    v_sub_f32 v167, 0, v7
    v_mov_b32 v95, 0
    v_mov_b32 v111, 0
    s_mov_b32 s84, s88
    s_mov_b32 s96, 32
L_fb2:
    buffer_load_dwordx4 v[112:115], v1, s[56:59], s84 offen sc1
    buffer_load_dwordx2 v[116:117], v4, s[56:59], s84 offen offset:2432 sc1
    buffer_load_dwordx4 v[120:123], v5, s[56:59], s84 offen offset:1024 sc1
    buffer_load_dwordx4 v[124:127], v5, s[56:59], s84 offen offset:1728 sc1
    s_waitcnt vmcnt(0)
    v_mfma_f32_32x32x16_bf16 v[32:47], v[112:115], v[10:13], v[136:151]
    v_mfma_f32_32x32x8bf16_1k v[32:47], v[116:117], v[14:15], v[32:47]
    v_mfma_f32_32x32x16_bf16 v[48:63], v[112:115], v[16:19], v[152:167]
    v_mfma_f32_32x32x8bf16_1k v[48:63], v[116:117], v[20:21], v[48:63]
    s_nop 11
    v_exp_f32 v32, v32
    v_exp_f32 v33, v33
    v_exp_f32 v34, v34
    v_exp_f32 v35, v35
    v_exp_f32 v36, v36
    v_exp_f32 v37, v37
    v_cvt_pk_bf16_f32 v64, v32, v33
    v_exp_f32 v38, v38
    v_exp_f32 v39, v39
    v_cvt_pk_bf16_f32 v65, v34, v35
    v_exp_f32 v40, v40
    v_exp_f32 v41, v41
    v_cvt_pk_bf16_f32 v66, v36, v37
    v_exp_f32 v42, v42
    v_exp_f32 v43, v43
    v_cvt_pk_bf16_f32 v67, v38, v39
    v_exp_f32 v44, v44
    v_exp_f32 v45, v45
    v_cvt_pk_bf16_f32 v68, v40, v41
    v_exp_f32 v46, v46
    v_exp_f32 v47, v47
    v_cvt_pk_bf16_f32 v69, v42, v43
    v_cvt_pk_bf16_f32 v70, v44, v45
    v_cvt_pk_bf16_f32 v71, v46, v47
    s_nop 1
    v_mfma_f32_32x32x16_bf16 v[80:95], v[120:123], v[64:67], v[80:95]
    v_mfma_f32_32x32x16_bf16 v[80:95], v[124:127], v[68:71], v[80:95]
    v_exp_f32 v48, v48
    v_exp_f32 v49, v49
    v_exp_f32 v50, v50
    v_exp_f32 v51, v51
    v_exp_f32 v52, v52
    v_exp_f32 v53, v53
    v_cvt_pk_bf16_f32 v72, v48, v49
    v_exp_f32 v54, v54
    v_exp_f32 v55, v55
    v_cvt_pk_bf16_f32 v73, v50, v51
    v_exp_f32 v56, v56
    v_exp_f32 v57, v57
    v_cvt_pk_bf16_f32 v74, v52, v53
    v_exp_f32 v58, v58
    v_exp_f32 v59, v59
    v_cvt_pk_bf16_f32 v75, v54, v55
    v_exp_f32 v60, v60
    v_exp_f32 v61, v61
    v_cvt_pk_bf16_f32 v76, v56, v57
    v_exp_f32 v62, v62
    v_exp_f32 v63, v63
    v_cvt_pk_bf16_f32 v77, v58, v59
    v_cvt_pk_bf16_f32 v78, v60, v61
    v_cvt_pk_bf16_f32 v79, v62, v63
    s_nop 1
    v_mfma_f32_32x32x16_bf16 v[96:111], v[120:123], v[72:75], v[96:111]
    v_mfma_f32_32x32x16_bf16 v[96:111], v[124:127], v[76:79], v[96:111]
    s_add_u32 s84, s84, 2688
    s_sub_u32 s96, s96, 1
    s_cmp_lg_u32 s96, 0
    s_cbranch_scc1 L_fb2
    s_mul_i32 s76, s70, 20480
    s_add_u32 s76, s76, 81920
    s_mul_i32 s77, s70, 30720
    s_add_u32 s77, s77, 43008
    s_mul_i32 s78, s70, 76800
    s_add_u32 s78, s78, 48128
    v_lshrrev_b32 v2, 5, v0
    v_lshlrev_b32 v2, 4, v2
    v_bfe_u32 v3, v0, 4, 1
    v_lshlrev_b32 v3, 2, v3
    v_bfe_u32 v4, v0, 2, 2
    v_add3_u32 v2, v2, v3, v4
    v_mul_u32_u24 v2, 160, v2
    v_and_b32 v3, 3, v0
    v_lshlrev_b32 v3, 3, v3
    v_add3_u32 v156, v2, v3, s76
    v_add3_u32 v157, v2, v3, s77
    v_add3_u32 v158, v2, v3, s78
    s_mul_i32 s76, s71, 81920
    s_mul_i32 s77, s69, 20480
    s_add_u32 s76, s76, s77
    s_mul_i32 s77, s70, 10240
    s_add_u32 s76, s76, s77
    s_add_u32 s76, s76, 3145728
    v_add_u32 v159, s76, v1
    s_lshl_b32 s76, s69, 4
    v_and_b32 v2, 15, v0
    v_add_u32 v2, s76, v2
    v_mul_u32_u24 v2, 160, v2
    v_lshrrev_b32 v3, 4, v0
    v_lshlrev_b32 v3, 3, v3
    v_add_u32 v2, v2, v3
    v_add_u32 v160, 24576, v2
    s_mul_i32 s76, s68, 960
    s_add_u32 s76, s76, 24576
    v_add_u32 v161, s76, v1
    v_mul_u32_u24 v2, 0x199a, v0
    v_lshrrev_b32 v2, 16, v2
    v_mul_u32_u24 v3, 10, v2
    v_sub_u32 v3, v0, v3
    v_lshlrev_b32 v3, 4, v3
    v_mul_u32_u24 v2, 2560, v2
    v_add_u32 v162, v2, v3
    v_lshrrev_b32 v2, 2, v0
    v_and_b32 v2, 3, v2
    s_lshl_b32 s76, s70, 2
    v_add_u32 v2, s76, v2
    v_lshlrev_b32 v2, 3, v2
    v_and_b32 v3, 1, v0
    v_bfe_u32 v4, v0, 1, 1
    v_lshlrev_b32 v4, 2, v4
    v_add3_u32 v2, v2, v3, v4
    s_and_b32 s76, s69, 2
    v_add_u32 v2, s76, v2
    v_lshlrev_b32 v163, 2, v2
    s_mul_i32 s76, s68, 3072
    s_add_u32 s76, s76, 0
    v_add_u32 v164, s76, v1
    s_xor_b32 s77, s68, 4
    s_mul_i32 s77, s77, 3072
    s_add_u32 s77, s77, 0
    v_add_u32 v165, s77, v1
    s_branch L_tail
L_B0:
    s_cmp_lt_u32 s69, s74
    s_cselect_b32 s101, 1, 0
    s_waitcnt lgkmcnt(0)
    s_mov_b32 s52, s14
    s_mov_b32 s53, s15
    s_mov_b32 s54, 2621440
    s_mov_b32 s55, 0x20000
    v_mul_u32_u24 v2, 0x199a, v0
    v_lshrrev_b32 v2, 16, v2
    v_mul_u32_u24 v3, 10, v2
    v_sub_u32 v3, v0, v3
    v_lshlrev_b32 v3, 4, v3
    v_mul_u32_u24 v2, 1280, v2
    v_add_u32 v2, v2, v3
    s_mul_i32 s80, s71, 81920
    s_mul_i32 s81, s72, 160
    s_add_u32 s80, s80, s81
    s_mul_i32 s81, s69, 23040
    s_add_u32 s80, s80, s81
    s_mul_i32 s82, s69, 2880
    s_mov_b32 exec_hi, 0x0fffffff
    s_add_u32 m0, s82, 143360
    s_add_u32 s81, s80, 0
    buffer_load_dwordx4 v2, s[52:55], s81 offen lds
    s_add_u32 m0, s82, 144320
    s_add_u32 s81, s80, 7680
    buffer_load_dwordx4 v2, s[52:55], s81 offen lds
    s_cmp_eq_u32 s69, 3
    s_cbranch_scc1 L_ut3
    s_add_u32 m0, s82, 145280
    s_add_u32 s81, s80, 15360
    buffer_load_dwordx4 v2, s[52:55], s81 offen lds
L_ut3:
    s_mov_b32 exec_hi, -1
    s_cmp_eq_u32 s101, 0
    s_cbranch_scc1 L_noparam
    s_add_u32 s82, s75, s69
    s_lshl_b32 s83, s82, 8
    v_lshlrev_b32 v2, 2, v0
    v_add_u32 v2, s83, v2
    s_lshl_b32 s82, s82, 1
    v_mov_b32 v3, s82
    global_load_dword v10, v2, s[16:17]
    global_load_dword v11, v2, s[18:19]
    global_load_dword v12, v2, s[20:21]
    global_load_dword v13, v2, s[22:23]
    global_load_ushort v14, v3, s[24:25]
    global_load_ushort v15, v3, s[26:27]
L_noparam:
    s_mov_b32 s56, s32
    s_mov_b32 s57, s33
    s_mov_b32 s58, 13631488
    s_mov_b32 s59, 0x20000
    s_mov_b32 s76, 0
    v_mov_b32 v2, 0
    buffer_load_dword v164, v2, s[56:59], s76 offen sc1
    s_barrier
    s_lshl_b32 s76, s69, 11
    s_add_u32 s76, s76, 153920
    v_lshrrev_b32 v2, 4, v0
    v_and_b32 v3, 3, v0
    v_bfe_u32 v4, v0, 2, 2
    v_lshlrev_b32 v5, 4, v2
    v_lshlrev_b32 v6, 2, v3
    v_add3_u32 v5, v5, v6, v4
    v_mul_u32_u24 v5, 160, v5
    s_mul_i32 s77, s69, 40
    s_add_u32 s77, s77, 143360
    v_add_u32 v128, s77, v5
    v_xor_b32 v5, v2, v3
    v_lshlrev_b32 v5, 5, v5
    v_lshlrev_b32 v6, 7, v3
    v_lshlrev_b32 v7, 3, v4
    v_add3_u32 v5, v5, v6, v7
    v_add_u32 v129, s76, v5
    v_bfe_u32 v2, v0, 3, 2
    v_bfe_u32 v3, v0, 1, 2
    v_xor_b32 v3, v3, v2
    v_lshlrev_b32 v3, 5, v3
    v_and_b32 v4, 1, v0
    v_lshlrev_b32 v4, 4, v4
    v_lshlrev_b32 v5, 7, v2
    v_add3_u32 v3, v3, v4, v5
    v_lshrrev_b32 v4, 5, v0
    v_lshlrev_b32 v5, 9, v4
    v_add3_u32 v130, v3, v5, s76
    v_lshrrev_b32 v2, 3, v0
    v_mul_u32_u24 v2, 4352, v2
    v_and_b32 v3, 7, v0
    v_lshlrev_b32 v3, 4, v3
    v_add_u32 v131, v2, v3
    s_mul_i32 s76, s72, 80
    s_mul_i32 s77, s69, 20
    s_add_u32 s76, s76, s77
    s_mul_i32 s76, s76, 4352
    s_lshl_b32 s77, s71, 7
    s_add_u32 s77, s77, s76
    s_add_u32 s86, s77, 262144
    s_mov_b32 s95, 43008
    s_cmp_eq_u32 s74, 2
    s_cselect_b32 s76, s69, 0
    s_and_b32 s76, s76, 1
    s_mul_i32 s76, s76, 17536
    s_add_u32 s95, s95, s76
    s_cmp_eq_u32 s101, 0
    s_cbranch_scc1 L_B_chb
    s_mov_b32 s95, 43008
    s_cmp_eq_u32 s69, 1
    s_cselect_b32 s95, 60544, s95
    s_cmp_eq_u32 s69, 2
    s_cselect_b32 s95, 124928, s95
    s_cmp_eq_u32 s69, 3
    s_cselect_b32 s95, 43008, s95
L_B_chb:
    s_add_u32 s76, s95, 9152
    v_and_b32 v2, 15, v0
    v_lshlrev_b32 v2, 5, v2
    v_lshrrev_b32 v3, 4, v0
    v_lshlrev_b32 v3, 3, v3
    v_add_u32 v2, v2, v3
    s_add_u32 s82, s76, 4088
    v_sub_u32 v160, s82, v2
    v_lshlrev_b32 v3, 3, v0
    s_add_u32 s82, s76, 4088-512
    v_sub_u32 v161, s82, v3
    s_add_u32 s82, s76, 3056
    v_sub_u32 v162, s82, v1
    v_lshlrev_b32 v5, 5, v0
    s_add_u32 s82, s76, 2016
    v_sub_u32 v163, s82, v5
    v_add_u32 v132, 4220, v160
    v_add_u32 v133, 4220, v161
    v_add_u32 v134, 4220, v162
    v_add_u32 v135, 4220, v163
    v_mov_b32 v152, 0
    v_mov_b32 v153, 0
    v_mov_b32 v154, 0
    v_mov_b32 v155, 0
    v_lshlrev_b32 v2, 2, v0
    v_add_u32 v92, s76, v2
    v_lshrrev_b32 v3, 5, v0
    v_mul_u32_u24 v3, 4064, v3
    v_add3_u32 v93, v3, v1, s95
    v_mov_b32 v114, s95
    v_and_b32 v2, 1, v0
    v_mul_u32_u24 v3, 4576, v2
    v_bfe_u32 v4, v0, 1, 3
    v_lshlrev_b32 v4, 6, v4
    v_lshrrev_b32 v5, 4, v0
    v_lshlrev_b32 v5, 4, v5
    v_add3_u32 v3, v3, v4, v5
    s_add_u32 s78, s95, 448
    v_add_u32 v94, s78, v3
    v_and_b32 v3, 15, v0
    v_lshlrev_b32 v3, 2, v3
    v_sub_u32 v3, v5, v3
    v_mul_u32_u24 v2, 4220, v2
    v_sub_u32 v3, v3, v2
    s_add_u32 s78, s95, 13880
    v_add_u32 v95, s78, v3
    s_mov_b32 s48, s12
    s_mov_b32 s49, s13
    s_mov_b32 s50, 819200
    s_mov_b32 s51, 0x20000
    s_mov_b32 s60, s28
    s_mov_b32 s61, s29
    s_mov_b32 s62, 5242880
    s_mov_b32 s63, 0x20000
    s_setprio 3
    s_waitcnt vmcnt(0)
    v_mov_b32 v2, 163388
    v_mov_b32 v3, 1
    s_mov_b64 exec, 1
    ds_add_u32 v2, v3
    s_mov_b64 exec, -1
    v_readfirstlane_b32 s3, v164
    s_nop 1
    s_add_u32 s3, s3, 0x9e3779b8
    s_and_b32 s3, s3, 0xfffffffc
    s_mov_b32 s97, 0
    v_mov_b32 v2, 163388
L_spinU0:
    ds_read_b32 v3, v2
    s_add_u32 s97, s97, 1
    s_cmp_gt_u32 s97, 0x1000000
    s_cbranch_scc1 L_spinU0_done
    s_waitcnt lgkmcnt(0)
    v_cmp_gt_u32 vcc, 4, v3
    s_cbranch_vccz L_spinU0_done
    s_sleep 1
    s_branch L_spinU0
L_spinU0_done:
    ds_read_b64_tr_b16 v[104:105], v128 offset:0
    ds_read_b64_tr_b16 v[106:107], v128 offset:8
    ds_read_b64_tr_b16 v[108:109], v128 offset:16
    ds_read_b64_tr_b16 v[110:111], v128 offset:24
    ds_read_b64_tr_b16 v[112:113], v128 offset:32
    s_waitcnt lgkmcnt(4)
    ds_write_b64 v129, v[104:105] offset:0
    s_waitcnt lgkmcnt(4)
    ds_write_b64 v129, v[106:107] offset:512
    s_waitcnt lgkmcnt(4)
    ds_write_b64 v129, v[108:109] offset:1024
    s_waitcnt lgkmcnt(4)
    ds_write_b64 v129, v[110:111] offset:1536
    ds_read_b128 v[116:119], v130
    ds_read_b128 v[120:123], v130 offset:1024
    s_waitcnt lgkmcnt(6)
    ds_write_b64 v129, v[112:113] offset:0
    ds_read_b128 v[124:127], v130
    s_waitcnt lgkmcnt(2)
    s_add_u32 s78, s86, 0
    buffer_store_dwordx4 v[116:119], v131, s[56:59], s78 offen sc1
    s_waitcnt lgkmcnt(2)
    s_add_u32 s78, s86, 34816
    buffer_store_dwordx4 v[120:123], v131, s[56:59], s78 offen sc1
    s_waitcnt lgkmcnt(0)
    s_mov_b32 exec_hi, 0
    s_add_u32 s78, s86, 69632
    buffer_store_dwordx4 v[124:127], v131, s[56:59], s78 offen sc1
    s_mov_b32 exec_hi, -1
    v_mov_b32 v2, 163412
    v_mov_b32 v3, 1
    s_mov_b64 exec, 1
    ds_add_u32 v2, v3
    s_mov_b64 exec, -1
    s_cmp_eq_u32 s101, 0
    s_cbranch_scc1 L_B_nogen
    s_setprio 2
    v_lshlrev_b32 v2, 16, v14
    v_mul_f32 v2, 0x3fb8aa3b, v2
    v_exp_f32 v2, v2
    s_nop 0
    v_cvt_pk_bf16_f32 v100, v2, v2
    v_and_b32 v100, 0xffff0000, v100
    s_mul_i32 s95, s69, 4096
    s_add_u32 s95, s95, 150784
    v_lshlrev_b32 v2, 6, v0
    v_bfe_u32 v3, v0, 1, 2
    v_lshlrev_b32 v3, 4, v3
    v_add3_u32 v96, v2, v3, s95
    v_xor_b32 v156, 16, v96
    v_xor_b32 v157, 32, v96
    v_xor_b32 v158, 48, v96
    v_lshrrev_b32 v2, 2, v0
    v_bfe_u32 v3, v0, 3, 2
    v_bfe_u32 v4, v0, 1, 1
    v_xor_b32 v3, v3, v4
    v_lshlrev_b32 v3, 4, v3
    v_lshlrev_b32 v2, 6, v2
    v_and_b32 v4, 1, v0
    v_lshlrev_b32 v4, 3, v4
    v_add3_u32 v2, v2, v3, v4
    v_add_u32 v97, s95, v2
    v_xor_b32 v159, 32, v97
    v_mov_b32 v16, 0
    v_mov_b32 v17, 0
    v_mov_b32 v18, 0
    v_mov_b32 v19, 0
    v_mov_b32 v20, 0
    v_mov_b32 v21, 0
    v_mov_b32 v22, 0
    v_mov_b32 v23, 0
    v_mov_b32 v24, 0
    v_mov_b32 v25, 0
    v_mov_b32 v26, 0
    v_mov_b32 v27, 0
    v_and_b32 v2, 0xffff0000, v10
    v_and_b32 v3, 0xffff0000, v11
    v_and_b32 v4, 0xffff0000, v12
    v_and_b32 v5, 0xffff0000, v13
    v_mul_f32 v2, 0x3fb8aa3b, v2
    v_exp_f32 v2, v2
    v_mul_f32 v3, v3, v100
    v_add_f32 v6, v100, v100
    v_cvt_pk_bf16_f32 v2, v2, v2
    v_and_b32 v2, 0xffff0000, v2
    v_mul_f32 v99, 0x3e22f983, v3
    v_mul_f32 v2, v2, v100
    v_mul_f32 v102, v4, v6
    v_mul_f32 v98, 0xbfb8aa3b, v2
    v_mul_f32 v103, v5, v6
    v_lshlrev_b32 v10, 16, v10
    v_lshlrev_b32 v11, 16, v11
    v_lshlrev_b32 v12, 16, v12
    v_lshlrev_b32 v13, 16, v13
    v_mul_f32 v2, 0x3f800000, v98
    v_mul_f32 v3, 0x3f800000, v99
    v_exp_f32 v2, v2
    v_fract_f32 v3, v3
    v_cos_f32 v4, v3
    v_sin_f32 v5, v3
    s_nop 0
    v_mul_f32 v60, v2, v4
    v_mul_f32 v61, v2, v5
    v_mul_f32 v2, 0x41800000, v98
    v_mul_f32 v3, 0x41800000, v99
    v_exp_f32 v2, v2
    v_fract_f32 v3, v3
    v_cos_f32 v4, v3
    v_sin_f32 v5, v3
    s_nop 0
    v_mul_f32 v62, v2, v4
    v_mul_f32 v63, v2, v5
    v_mul_f32 v2, 0x43800000, v98
    v_mul_f32 v3, 0x43800000, v99
    v_exp_f32 v2, v2
    v_fract_f32 v3, v3
    v_cos_f32 v4, v3
    v_sin_f32 v5, v3
    s_nop 0
    v_mul_f32 v64, v2, v4
    v_mul_f32 v65, v2, v5
    s_mov_b32 s97, 0
    v_mov_b32 v2, 163412
L_spinD:
    ds_read_b32 v3, v2
    s_add_u32 s97, s97, 1
    s_cmp_gt_u32 s97, 0x1000000
    s_cbranch_scc1 L_spinD_done
    s_waitcnt lgkmcnt(0)
    v_cmp_gt_u32 vcc, 4, v3
    s_cbranch_vccz L_spinD_done
    s_sleep 1
    s_branch L_spinD
L_spinD_done:
    s_mov_b32 s96, 2
L_kg:
    v_pk_mul_f32 v[72:73], v[102:103], v[62:63] op_sel:[0,0] op_sel_hi:[1,0]
    v_pk_fma_f32 v[72:73], v[102:103], v[62:63], v[72:73] op_sel:[1,1,0] op_sel_hi:[0,1,1] neg_lo:[0,1,0]
    v_cvt_pk_bf16_f32 v136, v102, v72
    v_cvt_pk_bf16_f32 v140, -v103, -v73
    v_pk_mul_f32 v[74:75], v[72:73], v[62:63] op_sel:[0,0] op_sel_hi:[1,0]
    v_pk_fma_f32 v[74:75], v[72:73], v[62:63], v[74:75] op_sel:[1,1,0] op_sel_hi:[0,1,1] neg_lo:[0,1,0]
    v_pk_mul_f32 v[72:73], v[74:75], v[62:63] op_sel:[0,0] op_sel_hi:[1,0]
    v_pk_fma_f32 v[72:73], v[74:75], v[62:63], v[72:73] op_sel:[1,1,0] op_sel_hi:[0,1,1] neg_lo:[0,1,0]
    v_cvt_pk_bf16_f32 v137, v74, v72
    v_cvt_pk_bf16_f32 v141, -v75, -v73
    v_pk_mul_f32 v[74:75], v[72:73], v[62:63] op_sel:[0,0] op_sel_hi:[1,0]
    v_pk_fma_f32 v[74:75], v[72:73], v[62:63], v[74:75] op_sel:[1,1,0] op_sel_hi:[0,1,1] neg_lo:[0,1,0]
    v_pk_mul_f32 v[72:73], v[74:75], v[62:63] op_sel:[0,0] op_sel_hi:[1,0]
    v_pk_fma_f32 v[72:73], v[74:75], v[62:63], v[72:73] op_sel:[1,1,0] op_sel_hi:[0,1,1] neg_lo:[0,1,0]
    v_cvt_pk_bf16_f32 v138, v74, v72
    v_cvt_pk_bf16_f32 v142, -v75, -v73
    v_pk_mul_f32 v[74:75], v[72:73], v[62:63] op_sel:[0,0] op_sel_hi:[1,0]
    v_pk_fma_f32 v[74:75], v[72:73], v[62:63], v[74:75] op_sel:[1,1,0] op_sel_hi:[0,1,1] neg_lo:[0,1,0]
    v_pk_mul_f32 v[72:73], v[74:75], v[62:63] op_sel:[0,0] op_sel_hi:[1,0]
    v_pk_fma_f32 v[72:73], v[74:75], v[62:63], v[72:73] op_sel:[1,1,0] op_sel_hi:[0,1,1] neg_lo:[0,1,0]
    v_cvt_pk_bf16_f32 v139, v74, v72
    v_cvt_pk_bf16_f32 v143, -v75, -v73
    ds_write_b128 v96, v[136:139]
    ds_write_b128 v157, v[140:143]
    v_pk_mul_f32 v[74:75], v[72:73], v[62:63] op_sel:[0,0] op_sel_hi:[1,0]
    v_pk_fma_f32 v[74:75], v[72:73], v[62:63], v[74:75] op_sel:[1,1,0] op_sel_hi:[0,1,1] neg_lo:[0,1,0]
    v_pk_mul_f32 v[72:73], v[74:75], v[62:63] op_sel:[0,0] op_sel_hi:[1,0]
    v_pk_fma_f32 v[72:73], v[74:75], v[62:63], v[72:73] op_sel:[1,1,0] op_sel_hi:[0,1,1] neg_lo:[0,1,0]
    v_cvt_pk_bf16_f32 v144, v74, v72
    v_cvt_pk_bf16_f32 v148, -v75, -v73
    v_pk_mul_f32 v[74:75], v[72:73], v[62:63] op_sel:[0,0] op_sel_hi:[1,0]
    v_pk_fma_f32 v[74:75], v[72:73], v[62:63], v[74:75] op_sel:[1,1,0] op_sel_hi:[0,1,1] neg_lo:[0,1,0]
    v_pk_mul_f32 v[72:73], v[74:75], v[62:63] op_sel:[0,0] op_sel_hi:[1,0]
    v_pk_fma_f32 v[72:73], v[74:75], v[62:63], v[72:73] op_sel:[1,1,0] op_sel_hi:[0,1,1] neg_lo:[0,1,0]
    v_cvt_pk_bf16_f32 v145, v74, v72
    v_cvt_pk_bf16_f32 v149, -v75, -v73
    v_pk_mul_f32 v[74:75], v[72:73], v[62:63] op_sel:[0,0] op_sel_hi:[1,0]
    v_pk_fma_f32 v[74:75], v[72:73], v[62:63], v[74:75] op_sel:[1,1,0] op_sel_hi:[0,1,1] neg_lo:[0,1,0]
    v_pk_mul_f32 v[72:73], v[74:75], v[62:63] op_sel:[0,0] op_sel_hi:[1,0]
    v_pk_fma_f32 v[72:73], v[74:75], v[62:63], v[72:73] op_sel:[1,1,0] op_sel_hi:[0,1,1] neg_lo:[0,1,0]
    v_cvt_pk_bf16_f32 v146, v74, v72
    v_cvt_pk_bf16_f32 v150, -v75, -v73
    v_pk_mul_f32 v[74:75], v[72:73], v[62:63] op_sel:[0,0] op_sel_hi:[1,0]
    v_pk_fma_f32 v[74:75], v[72:73], v[62:63], v[74:75] op_sel:[1,1,0] op_sel_hi:[0,1,1] neg_lo:[0,1,0]
    v_pk_mul_f32 v[72:73], v[74:75], v[62:63] op_sel:[0,0] op_sel_hi:[1,0]
    v_pk_fma_f32 v[72:73], v[74:75], v[62:63], v[72:73] op_sel:[1,1,0] op_sel_hi:[0,1,1] neg_lo:[0,1,0]
    v_cvt_pk_bf16_f32 v147, v74, v72
    v_cvt_pk_bf16_f32 v151, -v75, -v73
    ds_write_b128 v156, v[144:147]
    ds_write_b128 v158, v[148:151]
    ds_read_b64_tr_b16 v[28:29], v97 offset:0
    ds_read_b64_tr_b16 v[30:31], v159 offset:0
    ds_read_b64_tr_b16 v[32:33], v97 offset:1024
    ds_read_b64_tr_b16 v[34:35], v159 offset:1024
    ds_read_b64_tr_b16 v[36:37], v97 offset:2048
    ds_read_b64_tr_b16 v[38:39], v159 offset:2048
    ds_read_b64_tr_b16 v[40:41], v97 offset:3072
    ds_read_b64_tr_b16 v[42:43], v159 offset:3072
    v_cvt_pk_bf16_f32 v136, 1.0, v60
    v_cvt_pk_bf16_f32 v140, 0, v61
    v_pk_mul_f32 v[78:79], v[60:61], v[60:61] op_sel:[0,0] op_sel_hi:[1,0]
    v_pk_fma_f32 v[78:79], v[60:61], v[60:61], v[78:79] op_sel:[1,1,0] op_sel_hi:[0,1,1] neg_lo:[0,1,0]
    v_pk_mul_f32 v[72:73], v[78:79], v[60:61] op_sel:[0,0] op_sel_hi:[1,0]
    v_pk_fma_f32 v[72:73], v[78:79], v[60:61], v[72:73] op_sel:[1,1,0] op_sel_hi:[0,1,1] neg_lo:[0,1,0]
    v_cvt_pk_bf16_f32 v137, v78, v72
    v_cvt_pk_bf16_f32 v141, v79, v73
    v_pk_mul_f32 v[80:81], v[72:73], v[60:61] op_sel:[0,0] op_sel_hi:[1,0]
    v_pk_fma_f32 v[80:81], v[72:73], v[60:61], v[80:81] op_sel:[1,1,0] op_sel_hi:[0,1,1] neg_lo:[0,1,0]
    v_pk_mul_f32 v[72:73], v[80:81], v[60:61] op_sel:[0,0] op_sel_hi:[1,0]
    v_pk_fma_f32 v[72:73], v[80:81], v[60:61], v[72:73] op_sel:[1,1,0] op_sel_hi:[0,1,1] neg_lo:[0,1,0]
    v_cvt_pk_bf16_f32 v138, v80, v72
    v_cvt_pk_bf16_f32 v142, v81, v73
    v_pk_mul_f32 v[82:83], v[72:73], v[60:61] op_sel:[0,0] op_sel_hi:[1,0]
    v_pk_fma_f32 v[82:83], v[72:73], v[60:61], v[82:83] op_sel:[1,1,0] op_sel_hi:[0,1,1] neg_lo:[0,1,0]
    v_pk_mul_f32 v[72:73], v[82:83], v[60:61] op_sel:[0,0] op_sel_hi:[1,0]
    v_pk_fma_f32 v[72:73], v[82:83], v[60:61], v[72:73] op_sel:[1,1,0] op_sel_hi:[0,1,1] neg_lo:[0,1,0]
    v_cvt_pk_bf16_f32 v139, v82, v72
    v_cvt_pk_bf16_f32 v143, v83, v73
    ds_write_b128 v96, v[136:139]
    ds_write_b128 v157, v[140:143]
    v_pk_mul_f32 v[84:85], v[72:73], v[60:61] op_sel:[0,0] op_sel_hi:[1,0]
    v_pk_fma_f32 v[84:85], v[72:73], v[60:61], v[84:85] op_sel:[1,1,0] op_sel_hi:[0,1,1] neg_lo:[0,1,0]
    v_pk_mul_f32 v[72:73], v[84:85], v[60:61] op_sel:[0,0] op_sel_hi:[1,0]
    v_pk_fma_f32 v[72:73], v[84:85], v[60:61], v[72:73] op_sel:[1,1,0] op_sel_hi:[0,1,1] neg_lo:[0,1,0]
    v_cvt_pk_bf16_f32 v144, v84, v72
    v_cvt_pk_bf16_f32 v148, v85, v73
    v_pk_mul_f32 v[86:87], v[72:73], v[60:61] op_sel:[0,0] op_sel_hi:[1,0]
    v_pk_fma_f32 v[86:87], v[72:73], v[60:61], v[86:87] op_sel:[1,1,0] op_sel_hi:[0,1,1] neg_lo:[0,1,0]
    v_pk_mul_f32 v[72:73], v[86:87], v[60:61] op_sel:[0,0] op_sel_hi:[1,0]
    v_pk_fma_f32 v[72:73], v[86:87], v[60:61], v[72:73] op_sel:[1,1,0] op_sel_hi:[0,1,1] neg_lo:[0,1,0]
    v_cvt_pk_bf16_f32 v145, v86, v72
    v_cvt_pk_bf16_f32 v149, v87, v73
    v_pk_mul_f32 v[88:89], v[72:73], v[60:61] op_sel:[0,0] op_sel_hi:[1,0]
    v_pk_fma_f32 v[88:89], v[72:73], v[60:61], v[88:89] op_sel:[1,1,0] op_sel_hi:[0,1,1] neg_lo:[0,1,0]
    v_pk_mul_f32 v[72:73], v[88:89], v[60:61] op_sel:[0,0] op_sel_hi:[1,0]
    v_pk_fma_f32 v[72:73], v[88:89], v[60:61], v[72:73] op_sel:[1,1,0] op_sel_hi:[0,1,1] neg_lo:[0,1,0]
    v_cvt_pk_bf16_f32 v146, v88, v72
    v_cvt_pk_bf16_f32 v150, v89, v73
    v_pk_mul_f32 v[90:91], v[72:73], v[60:61] op_sel:[0,0] op_sel_hi:[1,0]
    v_pk_fma_f32 v[90:91], v[72:73], v[60:61], v[90:91] op_sel:[1,1,0] op_sel_hi:[0,1,1] neg_lo:[0,1,0]
    v_pk_mul_f32 v[72:73], v[90:91], v[60:61] op_sel:[0,0] op_sel_hi:[1,0]
    v_pk_fma_f32 v[72:73], v[90:91], v[60:61], v[72:73] op_sel:[1,1,0] op_sel_hi:[0,1,1] neg_lo:[0,1,0]
    v_cvt_pk_bf16_f32 v147, v90, v72
    v_cvt_pk_bf16_f32 v151, v91, v73
    ds_write_b128 v156, v[144:147]
    ds_write_b128 v158, v[148:151]
    ds_read_b64_tr_b16 v[44:45], v97 offset:0
    ds_read_b64_tr_b16 v[46:47], v159 offset:0
    ds_read_b64_tr_b16 v[48:49], v97 offset:1024
    ds_read_b64_tr_b16 v[50:51], v159 offset:1024
    ds_read_b64_tr_b16 v[52:53], v97 offset:2048
    ds_read_b64_tr_b16 v[54:55], v159 offset:2048
    ds_read_b64_tr_b16 v[56:57], v97 offset:3072
    ds_read_b64_tr_b16 v[58:59], v159 offset:3072
    v_pk_mul_f32 v[66:67], v[64:65], v[64:65] op_sel:[0,0] op_sel_hi:[1,0]
    v_pk_fma_f32 v[66:67], v[64:65], v[64:65], v[66:67] op_sel:[1,1,0] op_sel_hi:[0,1,1] neg_lo:[0,1,0]
    v_pk_mul_f32 v[68:69], v[66:67], v[64:65] op_sel:[0,0] op_sel_hi:[1,0]
    v_pk_fma_f32 v[68:69], v[66:67], v[64:65], v[68:69] op_sel:[1,1,0] op_sel_hi:[0,1,1] neg_lo:[0,1,0]
    v_pk_mul_f32 v[70:71], v[66:67], v[66:67] op_sel:[0,0] op_sel_hi:[1,0]
    v_pk_fma_f32 v[70:71], v[66:67], v[66:67], v[70:71] op_sel:[1,1,0] op_sel_hi:[0,1,1] neg_lo:[0,1,0]
    s_waitcnt lgkmcnt(6)
    v_mfma_f32_16x16x32_bf16 v[16:19], v[44:47], v[28:31], v[16:19]
    s_waitcnt lgkmcnt(4)
    v_mfma_f32_16x16x32_bf16 v[16:19], v[48:51], v[32:35], v[16:19]
    s_waitcnt lgkmcnt(2)
    v_mfma_f32_16x16x32_bf16 v[16:19], v[52:55], v[36:39], v[16:19]
    s_waitcnt lgkmcnt(0)
    v_mfma_f32_16x16x32_bf16 v[16:19], v[56:59], v[40:43], v[16:19]
    s_cmp_lg_u32 s96, 2
    s_cbranch_scc1 L_kg_ack
    s_waitcnt vmcnt(0)
    v_mov_b32 v2, 163348
    v_mov_b32 v3, 1
    s_mov_b64 exec, 1
    ds_add_u32 v2, v3
    s_mov_b64 exec, -1
L_kg_ack:
    v_pk_mul_f32 v[72:73], v[64:65], v[78:79] op_sel:[0,0] op_sel_hi:[1,0]
    v_pk_fma_f32 v[72:73], v[64:65], v[78:79], v[72:73] op_sel:[1,1,0] op_sel_hi:[0,1,1] neg_lo:[0,1,0]
    v_cvt_pk_bf16_f32 v136, v64, v72
    v_cvt_pk_bf16_f32 v140, v65, v73
    v_pk_mul_f32 v[74:75], v[64:65], v[80:81] op_sel:[0,0] op_sel_hi:[1,0]
    v_pk_fma_f32 v[74:75], v[64:65], v[80:81], v[74:75] op_sel:[1,1,0] op_sel_hi:[0,1,1] neg_lo:[0,1,0]
    v_pk_mul_f32 v[72:73], v[64:65], v[82:83] op_sel:[0,0] op_sel_hi:[1,0]
    v_pk_fma_f32 v[72:73], v[64:65], v[82:83], v[72:73] op_sel:[1,1,0] op_sel_hi:[0,1,1] neg_lo:[0,1,0]
    v_cvt_pk_bf16_f32 v137, v74, v72
    v_cvt_pk_bf16_f32 v141, v75, v73
    v_pk_mul_f32 v[74:75], v[64:65], v[84:85] op_sel:[0,0] op_sel_hi:[1,0]
    v_pk_fma_f32 v[74:75], v[64:65], v[84:85], v[74:75] op_sel:[1,1,0] op_sel_hi:[0,1,1] neg_lo:[0,1,0]
    v_pk_mul_f32 v[72:73], v[64:65], v[86:87] op_sel:[0,0] op_sel_hi:[1,0]
    v_pk_fma_f32 v[72:73], v[64:65], v[86:87], v[72:73] op_sel:[1,1,0] op_sel_hi:[0,1,1] neg_lo:[0,1,0]
    v_cvt_pk_bf16_f32 v138, v74, v72
    v_cvt_pk_bf16_f32 v142, v75, v73
    v_pk_mul_f32 v[74:75], v[64:65], v[88:89] op_sel:[0,0] op_sel_hi:[1,0]
    v_pk_fma_f32 v[74:75], v[64:65], v[88:89], v[74:75] op_sel:[1,1,0] op_sel_hi:[0,1,1] neg_lo:[0,1,0]
    v_pk_mul_f32 v[72:73], v[64:65], v[90:91] op_sel:[0,0] op_sel_hi:[1,0]
    v_pk_fma_f32 v[72:73], v[64:65], v[90:91], v[72:73] op_sel:[1,1,0] op_sel_hi:[0,1,1] neg_lo:[0,1,0]
    v_cvt_pk_bf16_f32 v139, v74, v72
    v_cvt_pk_bf16_f32 v143, v75, v73
    ds_write_b128 v96, v[136:139]
    ds_write_b128 v157, v[140:143]
    v_pk_mul_f32 v[72:73], v[66:67], v[80:81] op_sel:[0,0] op_sel_hi:[1,0]
    v_pk_fma_f32 v[72:73], v[66:67], v[80:81], v[72:73] op_sel:[1,1,0] op_sel_hi:[0,1,1] neg_lo:[0,1,0]
    v_cvt_pk_bf16_f32 v144, v66, v72
    v_cvt_pk_bf16_f32 v148, v67, v73
    v_pk_mul_f32 v[74:75], v[66:67], v[84:85] op_sel:[0,0] op_sel_hi:[1,0]
    v_pk_fma_f32 v[74:75], v[66:67], v[84:85], v[74:75] op_sel:[1,1,0] op_sel_hi:[0,1,1] neg_lo:[0,1,0]
    v_pk_mul_f32 v[72:73], v[66:67], v[88:89] op_sel:[0,0] op_sel_hi:[1,0]
    v_pk_fma_f32 v[72:73], v[66:67], v[88:89], v[72:73] op_sel:[1,1,0] op_sel_hi:[0,1,1] neg_lo:[0,1,0]
    v_cvt_pk_bf16_f32 v145, v74, v72
    v_cvt_pk_bf16_f32 v149, v75, v73
    v_pk_mul_f32 v[72:73], v[68:69], v[80:81] op_sel:[0,0] op_sel_hi:[1,0]
    v_pk_fma_f32 v[72:73], v[68:69], v[80:81], v[72:73] op_sel:[1,1,0] op_sel_hi:[0,1,1] neg_lo:[0,1,0]
    v_cvt_pk_bf16_f32 v146, v68, v72
    v_cvt_pk_bf16_f32 v150, v69, v73
    v_pk_mul_f32 v[74:75], v[68:69], v[84:85] op_sel:[0,0] op_sel_hi:[1,0]
    v_pk_fma_f32 v[74:75], v[68:69], v[84:85], v[74:75] op_sel:[1,1,0] op_sel_hi:[0,1,1] neg_lo:[0,1,0]
    v_pk_mul_f32 v[72:73], v[68:69], v[88:89] op_sel:[0,0] op_sel_hi:[1,0]
    v_pk_fma_f32 v[72:73], v[68:69], v[88:89], v[72:73] op_sel:[1,1,0] op_sel_hi:[0,1,1] neg_lo:[0,1,0]
    v_cvt_pk_bf16_f32 v147, v74, v72
    v_cvt_pk_bf16_f32 v151, v75, v73
    ds_write_b128 v156, v[144:147]
    ds_write_b128 v158, v[148:151]
    ds_read_b64_tr_b16 v[44:45], v97 offset:0
    ds_read_b64_tr_b16 v[46:47], v159 offset:0
    ds_read_b64_tr_b16 v[48:49], v97 offset:1024
    ds_read_b64_tr_b16 v[50:51], v159 offset:1024
    ds_read_b64_tr_b16 v[52:53], v97 offset:2048
    ds_read_b64_tr_b16 v[54:55], v159 offset:2048
    ds_read_b64_tr_b16 v[56:57], v97 offset:3072
    ds_read_b64_tr_b16 v[58:59], v159 offset:3072
    v_pk_mul_f32 v[72:73], v[70:71], v[84:85] op_sel:[0,0] op_sel_hi:[1,0]
    v_pk_fma_f32 v[72:73], v[70:71], v[84:85], v[72:73] op_sel:[1,1,0] op_sel_hi:[0,1,1] neg_lo:[0,1,0]
    v_cvt_pk_bf16_f32 v136, v70, v72
    v_cvt_pk_bf16_f32 v140, v71, v73
    v_pk_mul_f32 v[102:103], v[70:71], v[66:67] op_sel:[0,0] op_sel_hi:[1,0]
    v_pk_fma_f32 v[102:103], v[70:71], v[66:67], v[102:103] op_sel:[1,1,0] op_sel_hi:[0,1,1] neg_lo:[0,1,0]
    v_pk_mul_f32 v[74:75], v[70:71], v[64:65] op_sel:[0,0] op_sel_hi:[1,0]
    v_pk_fma_f32 v[74:75], v[70:71], v[64:65], v[74:75] op_sel:[1,1,0] op_sel_hi:[0,1,1] neg_lo:[0,1,0]
    v_pk_mul_f32 v[60:61], v[70:71], v[68:69] op_sel:[0,0] op_sel_hi:[1,0]
    v_pk_fma_f32 v[60:61], v[70:71], v[68:69], v[60:61] op_sel:[1,1,0] op_sel_hi:[0,1,1] neg_lo:[0,1,0]
    v_pk_mul_f32 v[72:73], v[74:75], v[84:85] op_sel:[0,0] op_sel_hi:[1,0]
    v_pk_fma_f32 v[72:73], v[74:75], v[84:85], v[72:73] op_sel:[1,1,0] op_sel_hi:[0,1,1] neg_lo:[0,1,0]
    v_cvt_pk_bf16_f32 v137, v74, v72
    v_cvt_pk_bf16_f32 v141, v75, v73
    s_waitcnt lgkmcnt(6)
    v_mfma_f32_16x16x32_bf16 v[20:23], v[44:47], v[28:31], v[20:23]
    s_waitcnt lgkmcnt(4)
    v_mfma_f32_16x16x32_bf16 v[20:23], v[48:51], v[32:35], v[20:23]
    s_waitcnt lgkmcnt(2)
    v_mfma_f32_16x16x32_bf16 v[20:23], v[52:55], v[36:39], v[20:23]
    s_waitcnt lgkmcnt(0)
    v_mfma_f32_16x16x32_bf16 v[20:23], v[56:59], v[40:43], v[20:23]
    v_pk_mul_f32 v[72:73], v[102:103], v[84:85] op_sel:[0,0] op_sel_hi:[1,0]
    v_pk_fma_f32 v[72:73], v[102:103], v[84:85], v[72:73] op_sel:[1,1,0] op_sel_hi:[0,1,1] neg_lo:[0,1,0]
    v_cvt_pk_bf16_f32 v138, v102, v72
    v_cvt_pk_bf16_f32 v142, v103, v73
    v_pk_mul_f32 v[72:73], v[60:61], v[84:85] op_sel:[0,0] op_sel_hi:[1,0]
    v_pk_fma_f32 v[72:73], v[60:61], v[84:85], v[72:73] op_sel:[1,1,0] op_sel_hi:[0,1,1] neg_lo:[0,1,0]
    v_pk_mul_f32 v[76:77], v[60:61], v[62:63] op_sel:[0,0] op_sel_hi:[1,0]
    v_pk_fma_f32 v[76:77], v[60:61], v[62:63], v[76:77] op_sel:[1,1,0] op_sel_hi:[0,1,1] neg_lo:[0,1,0]
    v_cvt_pk_bf16_f32 v139, v60, v72
    v_cvt_pk_bf16_f32 v143, v61, v73
    ds_write_b128 v96, v[136:139]
    ds_write_b128 v157, v[140:143]
    v_cvt_pk_bf16_f32 v144, v76, v76
    v_cvt_pk_bf16_f32 v145, v77, v77
    ds_write_b32 v156, v144
    ds_write_b32 v158, v145
    ds_read_b64_tr_b16 v[44:45], v97 offset:0
    ds_read_b64_tr_b16 v[46:47], v159 offset:0
    ds_read_b64_tr_b16 v[48:49], v97 offset:1024
    ds_read_b64_tr_b16 v[50:51], v159 offset:1024
    ds_read_b64_tr_b16 v[52:53], v97 offset:2048
    ds_read_b64_tr_b16 v[54:55], v159 offset:2048
    ds_read_b64_tr_b16 v[56:57], v97 offset:3072
    ds_read_b64_tr_b16 v[58:59], v159 offset:3072
    s_cmp_eq_u32 s96, 1
    s_cbranch_scc1 L_kg_nosetup
    v_and_b32 v2, 0xffff0000, v10
    v_and_b32 v3, 0xffff0000, v11
    v_and_b32 v4, 0xffff0000, v12
    v_and_b32 v5, 0xffff0000, v13
    v_mul_f32 v2, 0x3fb8aa3b, v2
    v_exp_f32 v2, v2
    v_mul_f32 v3, v3, v100
    v_add_f32 v6, v100, v100
    v_cvt_pk_bf16_f32 v2, v2, v2
    v_and_b32 v2, 0xffff0000, v2
    v_mul_f32 v99, 0x3e22f983, v3
    v_mul_f32 v2, v2, v100
    v_mul_f32 v102, v4, v6
    v_mul_f32 v98, 0xbfb8aa3b, v2
    v_mul_f32 v103, v5, v6
    v_lshlrev_b32 v10, 16, v10
    v_lshlrev_b32 v11, 16, v11
    v_lshlrev_b32 v12, 16, v12
    v_lshlrev_b32 v13, 16, v13
    v_mul_f32 v2, 0x3f800000, v98
    v_mul_f32 v3, 0x3f800000, v99
    v_exp_f32 v2, v2
    v_fract_f32 v3, v3
    v_cos_f32 v4, v3
    v_sin_f32 v5, v3
    s_nop 0
    v_mul_f32 v60, v2, v4
    v_mul_f32 v61, v2, v5
    v_mul_f32 v2, 0x41800000, v98
    v_mul_f32 v3, 0x41800000, v99
    v_exp_f32 v2, v2
    v_fract_f32 v3, v3
    v_cos_f32 v4, v3
    v_sin_f32 v5, v3
    s_nop 0
    v_mul_f32 v62, v2, v4
    v_mul_f32 v63, v2, v5
    v_mul_f32 v2, 0x43800000, v98
    v_mul_f32 v3, 0x43800000, v99
    v_exp_f32 v2, v2
    v_fract_f32 v3, v3
    v_cos_f32 v4, v3
    v_sin_f32 v5, v3
    s_nop 0
    v_mul_f32 v64, v2, v4
    v_mul_f32 v65, v2, v5
L_kg_nosetup:
    s_waitcnt lgkmcnt(6)
    v_mfma_f32_16x16x32_bf16 v[24:27], v[44:47], v[28:31], v[24:27]
    s_waitcnt lgkmcnt(4)
    v_mfma_f32_16x16x32_bf16 v[24:27], v[48:51], v[32:35], v[24:27]
    s_waitcnt lgkmcnt(2)
    v_mfma_f32_16x16x32_bf16 v[24:27], v[52:55], v[36:39], v[24:27]
    s_waitcnt lgkmcnt(0)
    v_mfma_f32_16x16x32_bf16 v[24:27], v[56:59], v[40:43], v[24:27]
    s_sub_u32 s96, s96, 1
    s_cmp_lg_u32 s96, 0
    s_cbranch_scc1 L_kg
    v_and_b32 v2, 15, v0
    v_lshrrev_b32 v3, 4, v0
    v_cmp_gt_u32 vcc, 32, v0
    v_lshlrev_b32 v4, 4, v2
    v_lshlrev_b32 v5, 3, v3
    v_add_u32 v4, v4, v5
    v_lshlrev_b32 v5, 7, v3
    v_lshlrev_b32 v6, 3, v2
    v_add_u32 v5, v5, v6
    v_cndmask_b32 v4, v5, v4, vcc
    v_add_u32 v4, s95, v4
    v_lshlrev_b32 v5, 7, v3
    v_lshlrev_b32 v6, 2, v2
    v_add3_u32 v5, v5, v6, s95
    v_lshlrev_b32 v6, 16, v15
    v_cmp_eq_u32 s[78:79], 0, v0
    v_lshlrev_b32 v8, 2, v0
    v_add_u32 v8, s95, v8
    v_cndmask_b32 v6, 0, v6, s[78:79]
    v_add_f32 v16, v16, v6
    v_cvt_pk_bf16_f32 v110, v19, v18
    v_cvt_pk_bf16_f32 v111, v17, v16
    v_cvt_pk_bf16_f32 v28, v20, v21
    v_cvt_pk_bf16_f32 v29, v22, v23
    v_cvt_pk_bf16_f32 v30, v24, v25
    v_cvt_pk_bf16_f32 v31, v26, v27
    v_mov_b32 v7, s95
    ds_write_b64 v4, v[28:29]
    s_mov_b64 exec, vcc
    ds_write2_b32 v5, v30, v31 offset0:128 offset1:144
    s_mov_b32 exec_lo, 0
    s_mov_b32 exec_hi, 0x8000
    ds_write_b32 v7, v30 offset:768
    s_mov_b64 exec, -1
    ds_read2_b32 v[104:105], v8 offset0:0 offset1:1
    ds_read2_b32 v[106:107], v8 offset0:64 offset1:65
    ds_read2_b32 v[108:109], v8 offset0:128 offset1:129
    s_waitcnt lgkmcnt(0)
    s_mov_b32 s95, 43008
    s_cmp_eq_u32 s69, 1
    s_cselect_b32 s95, 60544, s95
    s_cmp_eq_u32 s69, 2
    s_cselect_b32 s95, 124928, s95
    s_cmp_eq_u32 s69, 3
    s_cselect_b32 s95, 43008, s95
    s_mov_b32 s77, 0x01000100
    s_mov_b32 s78, 0x03020302
    s_mov_b32 s79, 0x03020504
    s_mov_b32 s81, 0x01000302
    v_perm_b32 v112, v105, v104, s79
    v_perm_b32 v113, v104, v104, s77
    v_perm_b32 v116, v107, v107, s77
    v_perm_b32 v117, v106, v106, s78
    v_perm_b32 v118, v106, v106, s81
    v_perm_b32 v119, v106, v106, s77
    v_perm_b32 v120, v109, v109, s77
    v_perm_b32 v121, v109, v109, s77
    v_perm_b32 v122, v108, v108, s78
    v_perm_b32 v123, v108, v108, s78
    v_perm_b32 v124, v108, v108, s78
    v_perm_b32 v125, v108, v108, s81
    v_perm_b32 v126, v108, v108, s77
    v_perm_b32 v127, v108, v108, s77
    s_branch L_B_gen
L_B_nogen:
    s_waitcnt vmcnt(0)
    v_mov_b32 v2, 163348
    v_mov_b32 v3, 1
    s_mov_b64 exec, 1
    ds_add_u32 v2, v3
    s_mov_b64 exec, -1
    s_cmp_lg_u32 s69, 3
    s_cbranch_scc1 L_nosig
    s_mov_b32 s97, 0
    v_mov_b32 v2, 163348
L_spinSk:
    ds_read_b32 v3, v2
    s_add_u32 s97, s97, 1
    s_cmp_gt_u32 s97, 0x1000000
    s_cbranch_scc1 L_spinSk_done
    s_waitcnt lgkmcnt(0)
    v_cmp_gt_u32 vcc, 8, v3
    s_cbranch_vccz L_spinSk_done
    s_sleep 1
    s_branch L_spinSk
L_spinSk_done:
    v_mov_b32 v2, 163456
    ds_read_b128 v[8:11], v2
    s_mov_b32 s78, 0x41800000
    s_mov_b32 s79, 0x43000000
    s_mov_b32 s80, 0x44800000
    s_mov_b32 s81, 0x4f800000
    s_lshl_b32 s76, s71, 3
    s_add_u32 s76, s76, s72
    s_lshl_b32 s76, s76, 6
    s_add_u32 s76, s76, 40960
    v_mov_b32 v7, s3
    v_mov_b32 v5, 0
    s_waitcnt lgkmcnt(0)
    v_add_f32 v8, v8, v9
    v_max_u32 v10, v10, v11
    v_cmp_nle_f32 s[82:83], v8, s78
    v_cmp_nle_f32 s[84:85], v8, s79
    v_cmp_nle_f32 s[86:87], v8, s80
    v_cmp_nle_f32 s[88:89], v10, s81
    v_or_b32 v9, 1, v7
    v_or_b32 v10, 2, v7
    v_or_b32 v11, 3, v7
    s_or_b64 s[86:87], s[86:87], s[88:89]
    v_cndmask_b32 v7, v7, v9, s[82:83]
    v_cndmask_b32 v7, v7, v10, s[84:85]
    v_cndmask_b32 v7, v7, v11, s[86:87]
    s_mov_b64 exec, 1
    buffer_store_dword v7, v5, s[56:59], s76 offen sc1
    s_mov_b64 exec, -1
L_nosig:
L_B_gen:
    v_mov_b32 v10, v94
    v_mov_b32 v11, v95
    v_mov_b64 v[16:17], 0
    v_mov_b64 v[18:19], 0
    v_mov_b64 v[20:21], 0
    v_mov_b64 v[22:23], 0
    v_mov_b64 v[24:25], 0
    v_mov_b64 v[26:27], 0
    v_mov_b64 v[28:29], 0
    v_mov_b64 v[30:31], 0
    v_mov_b64 v[32:33], 0
    v_mov_b64 v[34:35], 0
    v_mov_b64 v[36:37], 0
    v_mov_b64 v[38:39], 0
    v_mov_b64 v[40:41], 0
    v_mov_b64 v[42:43], 0
    v_mov_b64 v[44:45], 0
    v_mov_b64 v[46:47], 0
    v_mov_b64 v[48:49], 0
    v_mov_b64 v[50:51], 0
    v_add_u32 v12, 81920, v10
    v_add_u32 v13, 81920, v11
    s_setprio 3
    s_mov_b32 s97, 0
    v_mov_b32 v2, 163416
L_goB:
    ds_read_b32 v3, v2
    s_add_u32 s97, s97, 1
    s_cmp_gt_u32 s97, 0x1000000
    s_cbranch_scc1 L_goB_done
    s_waitcnt lgkmcnt(0)
    v_cmp_gt_u32 vcc, 8, v3
    s_cbranch_vccz L_goB_done
    s_sleep 1
    s_branch L_goB
L_goB_done:
    v_mov_b32 v8, 163428
    v_mov_b32 v9, 1
    s_mov_b32 s98, 1
    s_mov_b32 s99, 1
    s_cmp_eq_u32 s101, 0
    s_cbranch_scc1 L_B_nou
    s_mov_b32 s97, 0
    v_mov_b32 v2, 163408
L_spinQ:
    ds_read_b32 v3, v2
    s_add_u32 s97, s97, 1
    s_cmp_gt_u32 s97, 0x1000000
    s_cbranch_scc1 L_spinQ_done
    s_waitcnt lgkmcnt(0)
    v_cmp_gt_u32 vcc, 8, v3
    s_cbranch_vccz L_spinQ_done
    s_sleep 1
    s_branch L_spinQ
L_spinQ_done:
    s_add_u32 s77, s75, s69
    s_mul_i32 s77, s77, 4352
    s_add_u32 m0, s95, 5024
    s_add_u32 s78, s77, 262144
    buffer_load_dwordx4 v1, s[56:59], s78 offen sc1 lds
    s_add_u32 m0, s95, 6048
    s_add_u32 s78, s77, 263168
    buffer_load_dwordx4 v1, s[56:59], s78 offen sc1 lds
    s_add_u32 m0, s95, 7072
    s_add_u32 s78, s77, 264192
    buffer_load_dwordx4 v1, s[56:59], s78 offen sc1 lds
    s_add_u32 m0, s95, 8096
    s_add_u32 s78, s77, 265216
    buffer_load_dwordx4 v1, s[56:59], s78 offen sc1 lds
    s_add_u32 m0, s95, 448
    s_add_u32 s78, s77, 262142
    buffer_load_dwordx4 v1, s[56:59], s78 offen sc1 lds
    s_add_u32 m0, s95, 1472
    s_add_u32 s78, s77, 263166
    buffer_load_dwordx4 v1, s[56:59], s78 offen sc1 lds
    s_add_u32 m0, s95, 2496
    s_add_u32 s78, s77, 264190
    buffer_load_dwordx4 v1, s[56:59], s78 offen sc1 lds
    s_add_u32 m0, s95, 3520
    s_add_u32 s78, s77, 265214
    buffer_load_dwordx4 v1, s[56:59], s78 offen sc1 lds
    ds_write_b64 v160, v[110:111]
    ds_write_b64 v161, v[112:113]
    ds_write_b128 v162, v[116:119]
    ds_write_b128 v163, v[120:123]
    ds_write_b128 v163, v[124:127] offset:16
    ds_write2_b32 v132, v110, v111 offset0:0 offset1:1
    ds_write2_b32 v133, v112, v113 offset0:0 offset1:1
    ds_write2_b32 v134, v116, v117 offset0:0 offset1:1
    ds_write2_b32 v134, v118, v119 offset0:2 offset1:3
    ds_write2_b32 v135, v120, v121 offset0:0 offset1:1
    ds_write2_b32 v135, v122, v123 offset0:2 offset1:3
    ds_write2_b32 v135, v124, v125 offset0:4 offset1:5
    ds_write2_b32 v135, v126, v127 offset0:6 offset1:7
    s_mov_b32 exec_hi, 0
    s_mov_b32 exec_lo, 0xffff
    ds_write_b32 v92, v152 offset:4096
    ds_write_b32 v92, v152 offset:8316
    s_mov_b32 exec_lo, 0x0fffffff
    s_mov_b32 exec_hi, 0x0fffffff
    ds_write_b128 v93, v[152:155]
    s_mov_b64 exec, -1
L_B_nou:
    s_getpc_b64 s[90:91]
    s_add_u32 s90, s90, 12
    s_addc_u32 s91, s91, 0
    s_branch L_stage_all
    s_cmp_eq_u32 s101, 0
    s_cbranch_scc1 L_B_helper
    s_waitcnt vmcnt(11)
    s_mov_b64 exec, 1
    ds_write_b16 v114, v152 offset:448
    s_mov_b64 exec, -1
    v_mov_b32 v2, 163340
    v_mov_b32 v3, 1
    s_waitcnt lgkmcnt(0)
    ds_add_u32 v2, v3
    s_setprio 0
    s_lshr_b32 s84, s2, 3
    s_lshl_b32 s84, s84, 2
    s_add_u32 s84, s84, s69
    s_mul_i32 s84, s84, 6400
    v_lshlrev_b32 v2, 7, v0
    s_mov_b32 exec_hi, 0x3ffff
    buffer_load_dword v14, v2, s[48:51], s84 offen
    s_mov_b32 exec_hi, -1
    s_mul_i32 s84, s71, 81920
    s_mul_i32 s85, s72, 10240
    s_add_u32 s84, s84, s85
    s_mul_i32 s85, s69, 2560
    s_add_u32 s84, s84, s85
    s_add_u32 s84, s84, 3145728
    s_mov_b32 exec_hi, 0
    s_mov_b32 exec_lo, 0xfffff
    buffer_load_dword v14, v2, s[56:59], s84 offen
    s_mov_b64 exec, -1
    s_cmp_eq_u32 s74, 2
    s_cbranch_scc1 L_B_two_a
    ds_read_b64 v[68:69], v11 offset:3584
    ds_read_b64 v[70:71], v11 offset:3592
    ds_read_b128 v[36:39], v10 offset:0
    ds_read_b64 v[72:73], v11 offset:3072
    ds_read_b64 v[74:75], v11 offset:3080
    ds_read_b128 v[40:43], v10 offset:512
    ds_read_b64 v[76:77], v11 offset:2560
    ds_read_b64 v[78:79], v11 offset:2568
    ds_read_b128 v[44:47], v10 offset:1024
    ds_read_b64 v[80:81], v11 offset:2048
    ds_read_b64 v[82:83], v11 offset:2056
    ds_read_b128 v[48:51], v10 offset:1536
    ds_read_b64 v[84:85], v11 offset:1536
    ds_read_b64 v[86:87], v11 offset:1544
    ds_read_b128 v[52:55], v10 offset:2048
    ds_read_b64 v[88:89], v11 offset:1024
    ds_read_b64 v[90:91], v11 offset:1032
    ds_read_b128 v[56:59], v10 offset:2560
    ds_read_b64 v[92:93], v11 offset:512
    ds_read_b64 v[94:95], v11 offset:520
    ds_read_b128 v[60:63], v10 offset:3072
    ds_read_b64 v[96:97], v11 offset:0
    ds_read_b64 v[98:99], v11 offset:8
    ds_read_b128 v[64:67], v10 offset:3584
    v_add_u32 v11, -64, v11
    v_add_u32 v10, -64, v10
    s_mov_b32 s96, 4
L_cvA:
    s_waitcnt lgkmcnt(0)
    v_mfma_f32_16x16x32_bf16 v[16:19], v[44:47], v[72:75], v[16:19]
    ds_read_b64 v[132:133], v11 offset:3584
    v_mfma_f32_16x16x32_bf16 v[16:19], v[40:43], v[76:79], v[16:19]
    ds_read_b64 v[134:135], v11 offset:3592
    v_mfma_f32_16x16x32_bf16 v[20:23], v[44:47], v[76:79], v[20:23]
    ds_read_b128 v[100:103], v10 offset:0
    v_mfma_f32_16x16x32_bf16 v[16:19], v[48:51], v[68:71], v[16:19]
    ds_read_b64 v[136:137], v11 offset:3072
    v_mfma_f32_16x16x32_bf16 v[20:23], v[48:51], v[72:75], v[20:23]
    ds_read_b64 v[138:139], v11 offset:3080
    v_mfma_f32_16x16x32_bf16 v[24:27], v[48:51], v[76:79], v[24:27]
    ds_read_b128 v[104:107], v10 offset:512
    v_mfma_f32_16x16x32_bf16 v[16:19], v[36:39], v[80:83], v[16:19]
    ds_read_b64 v[140:141], v11 offset:2560
    v_mfma_f32_16x16x32_bf16 v[20:23], v[40:43], v[80:83], v[20:23]
    ds_read_b64 v[142:143], v11 offset:2568
    v_mfma_f32_16x16x32_bf16 v[24:27], v[44:47], v[80:83], v[24:27]
    ds_read_b128 v[108:111], v10 offset:1024
    v_mfma_f32_16x16x32_bf16 v[28:31], v[48:51], v[80:83], v[28:31]
    ds_read_b64 v[144:145], v11 offset:2048
    v_mfma_f32_16x16x32_bf16 v[20:23], v[52:55], v[68:71], v[20:23]
    ds_read_b64 v[146:147], v11 offset:2056
    v_mfma_f32_16x16x32_bf16 v[24:27], v[52:55], v[72:75], v[24:27]
    ds_read_b128 v[112:115], v10 offset:1536
    v_mfma_f32_16x16x32_bf16 v[28:31], v[52:55], v[76:79], v[28:31]
    ds_read_b64 v[148:149], v11 offset:1536
    v_mfma_f32_16x16x32_bf16 v[32:35], v[52:55], v[80:83], v[32:35]
    ds_read_b64 v[150:151], v11 offset:1544
    v_mfma_f32_16x16x32_bf16 v[20:23], v[36:39], v[84:87], v[20:23]
    ds_read_b128 v[116:119], v10 offset:2048
    v_mfma_f32_16x16x32_bf16 v[24:27], v[40:43], v[84:87], v[24:27]
    ds_read_b64 v[152:153], v11 offset:1024
    v_mfma_f32_16x16x32_bf16 v[28:31], v[44:47], v[84:87], v[28:31]
    ds_read_b64 v[154:155], v11 offset:1032
    v_mfma_f32_16x16x32_bf16 v[32:35], v[48:51], v[84:87], v[32:35]
    ds_read_b128 v[120:123], v10 offset:2560
    v_mfma_f32_16x16x32_bf16 v[24:27], v[56:59], v[68:71], v[24:27]
    ds_read_b64 v[156:157], v11 offset:512
    v_mfma_f32_16x16x32_bf16 v[28:31], v[56:59], v[72:75], v[28:31]
    ds_read_b64 v[158:159], v11 offset:520
    v_mfma_f32_16x16x32_bf16 v[32:35], v[56:59], v[76:79], v[32:35]
    ds_read_b128 v[124:127], v10 offset:3072
    v_mfma_f32_16x16x32_bf16 v[24:27], v[36:39], v[88:91], v[24:27]
    ds_read_b64 v[160:161], v11 offset:0
    v_mfma_f32_16x16x32_bf16 v[28:31], v[40:43], v[88:91], v[28:31]
    ds_read_b64 v[162:163], v11 offset:8
    v_mfma_f32_16x16x32_bf16 v[32:35], v[44:47], v[88:91], v[32:35]
    ds_read_b128 v[128:131], v10 offset:3584
    v_mfma_f32_16x16x32_bf16 v[28:31], v[60:63], v[68:71], v[28:31]
    v_add_u32 v11, -64, v11
    v_add_u32 v10, -64, v10
    v_mfma_f32_16x16x32_bf16 v[32:35], v[60:63], v[72:75], v[32:35]
    v_mfma_f32_16x16x32_bf16 v[28:31], v[36:39], v[92:95], v[28:31]
    v_mfma_f32_16x16x32_bf16 v[32:35], v[40:43], v[92:95], v[32:35]
    v_mfma_f32_16x16x32_bf16 v[32:35], v[64:67], v[68:71], v[32:35]
    v_mfma_f32_16x16x32_bf16 v[32:35], v[36:39], v[96:99], v[32:35]
L_sv0:
    s_cmp_eq_u32 s99, 0
    s_cbranch_scc1 L_sv0_a
    s_waitcnt vmcnt(0)
    s_mov_b64 exec, 1
    ds_add_u32 v8, v9
    s_mov_b64 exec, -1
    v_add_u32 v8, 4, v8
    s_waitcnt lgkmcnt(0)
    s_add_u32 s98, s98, 1
    s_mov_b32 s99, 0
L_sv0_a:
    s_cmp_gt_u32 s98, 3
    s_cbranch_scc1 L_sv0_z
    ds_read_b32 v3, v8 offset:8
    s_waitcnt lgkmcnt(0)
    v_cmp_gt_u32 vcc, 8, v3
    s_cbranch_vccnz L_sv0_n
    s_getpc_b64 s[90:91]
    s_add_u32 s90, s90, 12
    s_addc_u32 s91, s91, 0
    s_branch L_stage_all
    s_mov_b32 s99, 1
L_sv0_n:
L_sv0_z:
    s_waitcnt lgkmcnt(0)
    v_mfma_f32_16x16x32_bf16 v[16:19], v[108:111], v[136:139], v[16:19]
    ds_read_b64 v[68:69], v11 offset:3584
    v_mfma_f32_16x16x32_bf16 v[16:19], v[104:107], v[140:143], v[16:19]
    ds_read_b64 v[70:71], v11 offset:3592
    v_mfma_f32_16x16x32_bf16 v[20:23], v[108:111], v[140:143], v[20:23]
    ds_read_b128 v[36:39], v10 offset:0
    v_mfma_f32_16x16x32_bf16 v[16:19], v[112:115], v[132:135], v[16:19]
    ds_read_b64 v[72:73], v11 offset:3072
    v_mfma_f32_16x16x32_bf16 v[20:23], v[112:115], v[136:139], v[20:23]
    ds_read_b64 v[74:75], v11 offset:3080
    v_mfma_f32_16x16x32_bf16 v[24:27], v[112:115], v[140:143], v[24:27]
    ds_read_b128 v[40:43], v10 offset:512
    v_mfma_f32_16x16x32_bf16 v[16:19], v[100:103], v[144:147], v[16:19]
    ds_read_b64 v[76:77], v11 offset:2560
    v_mfma_f32_16x16x32_bf16 v[20:23], v[104:107], v[144:147], v[20:23]
    ds_read_b64 v[78:79], v11 offset:2568
    v_mfma_f32_16x16x32_bf16 v[24:27], v[108:111], v[144:147], v[24:27]
    ds_read_b128 v[44:47], v10 offset:1024
    v_mfma_f32_16x16x32_bf16 v[28:31], v[112:115], v[144:147], v[28:31]
    ds_read_b64 v[80:81], v11 offset:2048
    v_mfma_f32_16x16x32_bf16 v[20:23], v[116:119], v[132:135], v[20:23]
    ds_read_b64 v[82:83], v11 offset:2056
    v_mfma_f32_16x16x32_bf16 v[24:27], v[116:119], v[136:139], v[24:27]
    ds_read_b128 v[48:51], v10 offset:1536
    v_mfma_f32_16x16x32_bf16 v[28:31], v[116:119], v[140:143], v[28:31]
    ds_read_b64 v[84:85], v11 offset:1536
    v_mfma_f32_16x16x32_bf16 v[32:35], v[116:119], v[144:147], v[32:35]
    ds_read_b64 v[86:87], v11 offset:1544
    v_mfma_f32_16x16x32_bf16 v[20:23], v[100:103], v[148:151], v[20:23]
    ds_read_b128 v[52:55], v10 offset:2048
    v_mfma_f32_16x16x32_bf16 v[24:27], v[104:107], v[148:151], v[24:27]
    ds_read_b64 v[88:89], v11 offset:1024
    v_mfma_f32_16x16x32_bf16 v[28:31], v[108:111], v[148:151], v[28:31]
    ds_read_b64 v[90:91], v11 offset:1032
    v_mfma_f32_16x16x32_bf16 v[32:35], v[112:115], v[148:151], v[32:35]
    ds_read_b128 v[56:59], v10 offset:2560
    v_mfma_f32_16x16x32_bf16 v[24:27], v[120:123], v[132:135], v[24:27]
    ds_read_b64 v[92:93], v11 offset:512
    v_mfma_f32_16x16x32_bf16 v[28:31], v[120:123], v[136:139], v[28:31]
    ds_read_b64 v[94:95], v11 offset:520
    v_mfma_f32_16x16x32_bf16 v[32:35], v[120:123], v[140:143], v[32:35]
    ds_read_b128 v[60:63], v10 offset:3072
    v_mfma_f32_16x16x32_bf16 v[24:27], v[100:103], v[152:155], v[24:27]
    ds_read_b64 v[96:97], v11 offset:0
    v_mfma_f32_16x16x32_bf16 v[28:31], v[104:107], v[152:155], v[28:31]
    ds_read_b64 v[98:99], v11 offset:8
    v_mfma_f32_16x16x32_bf16 v[32:35], v[108:111], v[152:155], v[32:35]
    ds_read_b128 v[64:67], v10 offset:3584
    v_mfma_f32_16x16x32_bf16 v[28:31], v[124:127], v[132:135], v[28:31]
    v_add_u32 v11, -64, v11
    v_add_u32 v10, -64, v10
    v_mfma_f32_16x16x32_bf16 v[32:35], v[124:127], v[136:139], v[32:35]
    v_mfma_f32_16x16x32_bf16 v[28:31], v[100:103], v[156:159], v[28:31]
    v_mfma_f32_16x16x32_bf16 v[32:35], v[104:107], v[156:159], v[32:35]
    v_mfma_f32_16x16x32_bf16 v[32:35], v[128:131], v[132:135], v[32:35]
    v_mfma_f32_16x16x32_bf16 v[32:35], v[100:103], v[160:163], v[32:35]
L_sv1:
    s_cmp_eq_u32 s99, 0
    s_cbranch_scc1 L_sv1_a
    s_waitcnt vmcnt(0)
    s_mov_b64 exec, 1
    ds_add_u32 v8, v9
    s_mov_b64 exec, -1
    v_add_u32 v8, 4, v8
    s_waitcnt lgkmcnt(0)
    s_add_u32 s98, s98, 1
    s_mov_b32 s99, 0
L_sv1_a:
    s_cmp_gt_u32 s98, 3
    s_cbranch_scc1 L_sv1_z
    ds_read_b32 v3, v8 offset:8
    s_waitcnt lgkmcnt(0)
    v_cmp_gt_u32 vcc, 8, v3
    s_cbranch_vccnz L_sv1_n
    s_getpc_b64 s[90:91]
    s_add_u32 s90, s90, 12
    s_addc_u32 s91, s91, 0
    s_branch L_stage_all
    s_mov_b32 s99, 1
L_sv1_n:
L_sv1_z:
    s_sub_u32 s96, s96, 1
    s_cmp_lg_u32 s96, 0
    s_cbranch_scc1 L_cvA
    s_waitcnt lgkmcnt(0)
    s_setprio 3
    v_lshrrev_b32 v2, 4, v0
    v_lshlrev_b32 v2, 7, v2
    v_and_b32 v3, 15, v0
    v_lshlrev_b32 v3, 2, v3
    v_add_u32 v2, v2, v3
    s_nop 3
    v_cvt_pk_bf16_f32 v60, v16, v17
    v_cvt_pk_bf16_f32 v61, v18, v19
    s_add_u32 s76, s75, s69
    s_mul_i32 s76, s76, 4352
    s_add_u32 s76, s76, 5767168
    buffer_store_dword v60, v2, s[56:59], s76 offen offset:1536 sc1
    buffer_store_dword v61, v2, s[56:59], s76 offen offset:1600 sc1
    v_cvt_pk_bf16_f32 v62, v20, v21
    v_cvt_pk_bf16_f32 v63, v22, v23
    buffer_store_dword v62, v2, s[56:59], s76 offen offset:2048 sc1
    buffer_store_dword v63, v2, s[56:59], s76 offen offset:2112 sc1
    v_cvt_pk_bf16_f32 v64, v24, v25
    v_cvt_pk_bf16_f32 v65, v26, v27
    buffer_store_dword v64, v2, s[56:59], s76 offen offset:2560 sc1
    buffer_store_dword v65, v2, s[56:59], s76 offen offset:2624 sc1
    v_cvt_pk_bf16_f32 v66, v28, v29
    v_cvt_pk_bf16_f32 v67, v30, v31
    buffer_store_dword v66, v2, s[56:59], s76 offen offset:3072 sc1
    buffer_store_dword v67, v2, s[56:59], s76 offen offset:3136 sc1
    v_cvt_pk_bf16_f32 v68, v32, v33
    v_cvt_pk_bf16_f32 v69, v34, v35
    buffer_store_dword v68, v2, s[56:59], s76 offen offset:3584 sc1
    buffer_store_dword v69, v2, s[56:59], s76 offen offset:3648 sc1
    s_branch L_B_sig
L_B_two_a:
    ds_read_b64 v[68:69], v11 offset:3584
    ds_read_b64 v[70:71], v11 offset:3592
    ds_read_b128 v[36:39], v10 offset:0
    ds_read_b64 v[72:73], v11 offset:3072
    ds_read_b64 v[74:75], v11 offset:3080
    ds_read_b128 v[40:43], v10 offset:512
    ds_read_b64 v[76:77], v11 offset:2560
    ds_read_b64 v[78:79], v11 offset:2568
    ds_read_b128 v[44:47], v10 offset:1024
    ds_read_b64 v[80:81], v11 offset:2048
    ds_read_b64 v[82:83], v11 offset:2056
    ds_read_b128 v[48:51], v10 offset:1536
    ds_read_b64 v[84:85], v11 offset:1536
    ds_read_b64 v[86:87], v11 offset:1544
    ds_read_b128 v[52:55], v10 offset:2048
    ds_read_b64 v[88:89], v11 offset:1024
    ds_read_b64 v[90:91], v11 offset:1032
    ds_read_b128 v[56:59], v10 offset:2560
    ds_read_b64 v[92:93], v11 offset:512
    ds_read_b64 v[94:95], v11 offset:520
    ds_read_b128 v[60:63], v10 offset:3072
    v_add_u32 v11, -64, v11
    v_add_u32 v10, -64, v10
    s_mov_b32 s96, 4
L_cvB:
    s_waitcnt lgkmcnt(0)
    v_mfma_f32_16x16x32_bf16 v[16:19], v[44:47], v[76:79], v[16:19]
    ds_read_b64 v[132:133], v11 offset:3584
    ds_read_b64 v[134:135], v11 offset:3592
    v_mfma_f32_16x16x32_bf16 v[16:19], v[48:51], v[72:75], v[16:19]
    ds_read_b128 v[100:103], v10 offset:0
    ds_read_b64 v[136:137], v11 offset:3072
    v_mfma_f32_16x16x32_bf16 v[20:23], v[48:51], v[76:79], v[20:23]
    ds_read_b64 v[138:139], v11 offset:3080
    ds_read_b128 v[104:107], v10 offset:512
    v_mfma_f32_16x16x32_bf16 v[16:19], v[40:43], v[80:83], v[16:19]
    ds_read_b64 v[140:141], v11 offset:2560
    ds_read_b64 v[142:143], v11 offset:2568
    v_mfma_f32_16x16x32_bf16 v[20:23], v[44:47], v[80:83], v[20:23]
    ds_read_b128 v[108:111], v10 offset:1024
    ds_read_b64 v[144:145], v11 offset:2048
    v_mfma_f32_16x16x32_bf16 v[24:27], v[48:51], v[80:83], v[24:27]
    ds_read_b64 v[146:147], v11 offset:2056
    ds_read_b128 v[112:115], v10 offset:1536
    v_mfma_f32_16x16x32_bf16 v[16:19], v[52:55], v[68:71], v[16:19]
    ds_read_b64 v[148:149], v11 offset:1536
    ds_read_b64 v[150:151], v11 offset:1544
    v_mfma_f32_16x16x32_bf16 v[20:23], v[52:55], v[72:75], v[20:23]
    ds_read_b128 v[116:119], v10 offset:2048
    ds_read_b64 v[152:153], v11 offset:1024
    v_mfma_f32_16x16x32_bf16 v[24:27], v[52:55], v[76:79], v[24:27]
    ds_read_b64 v[154:155], v11 offset:1032
    ds_read_b128 v[120:123], v10 offset:2560
    v_mfma_f32_16x16x32_bf16 v[16:19], v[36:39], v[84:87], v[16:19]
    ds_read_b64 v[156:157], v11 offset:512
    ds_read_b64 v[158:159], v11 offset:520
    v_mfma_f32_16x16x32_bf16 v[20:23], v[40:43], v[84:87], v[20:23]
    ds_read_b128 v[124:127], v10 offset:3072
    v_add_u32 v11, -64, v11
    v_add_u32 v10, -64, v10
    v_mfma_f32_16x16x32_bf16 v[24:27], v[44:47], v[84:87], v[24:27]
    v_mfma_f32_16x16x32_bf16 v[20:23], v[56:59], v[68:71], v[20:23]
    v_mfma_f32_16x16x32_bf16 v[24:27], v[56:59], v[72:75], v[24:27]
    v_mfma_f32_16x16x32_bf16 v[20:23], v[36:39], v[88:91], v[20:23]
    v_mfma_f32_16x16x32_bf16 v[24:27], v[40:43], v[88:91], v[24:27]
    v_mfma_f32_16x16x32_bf16 v[24:27], v[60:63], v[68:71], v[24:27]
    v_mfma_f32_16x16x32_bf16 v[24:27], v[36:39], v[92:95], v[24:27]
L_sv2:
    s_cmp_eq_u32 s99, 0
    s_cbranch_scc1 L_sv2_a
    s_waitcnt vmcnt(0)
    s_mov_b64 exec, 1
    ds_add_u32 v8, v9
    s_mov_b64 exec, -1
    v_add_u32 v8, 4, v8
    s_waitcnt lgkmcnt(0)
    s_add_u32 s98, s98, 1
    s_mov_b32 s99, 0
L_sv2_a:
    s_cmp_gt_u32 s98, 3
    s_cbranch_scc1 L_sv2_z
    ds_read_b32 v3, v8 offset:8
    s_waitcnt lgkmcnt(0)
    v_cmp_gt_u32 vcc, 8, v3
    s_cbranch_vccnz L_sv2_n
    s_getpc_b64 s[90:91]
    s_add_u32 s90, s90, 12
    s_addc_u32 s91, s91, 0
    s_branch L_stage_all
    s_mov_b32 s99, 1
L_sv2_n:
L_sv2_z:
    s_waitcnt lgkmcnt(0)
    v_mfma_f32_16x16x32_bf16 v[16:19], v[108:111], v[140:143], v[16:19]
    ds_read_b64 v[68:69], v11 offset:3584
    ds_read_b64 v[70:71], v11 offset:3592
    v_mfma_f32_16x16x32_bf16 v[16:19], v[112:115], v[136:139], v[16:19]
    ds_read_b128 v[36:39], v10 offset:0
    ds_read_b64 v[72:73], v11 offset:3072
    v_mfma_f32_16x16x32_bf16 v[20:23], v[112:115], v[140:143], v[20:23]
    ds_read_b64 v[74:75], v11 offset:3080
    ds_read_b128 v[40:43], v10 offset:512
    v_mfma_f32_16x16x32_bf16 v[16:19], v[104:107], v[144:147], v[16:19]
    ds_read_b64 v[76:77], v11 offset:2560
    ds_read_b64 v[78:79], v11 offset:2568
    v_mfma_f32_16x16x32_bf16 v[20:23], v[108:111], v[144:147], v[20:23]
    ds_read_b128 v[44:47], v10 offset:1024
    ds_read_b64 v[80:81], v11 offset:2048
    v_mfma_f32_16x16x32_bf16 v[24:27], v[112:115], v[144:147], v[24:27]
    ds_read_b64 v[82:83], v11 offset:2056
    ds_read_b128 v[48:51], v10 offset:1536
    v_mfma_f32_16x16x32_bf16 v[16:19], v[116:119], v[132:135], v[16:19]
    ds_read_b64 v[84:85], v11 offset:1536
    ds_read_b64 v[86:87], v11 offset:1544
    v_mfma_f32_16x16x32_bf16 v[20:23], v[116:119], v[136:139], v[20:23]
    ds_read_b128 v[52:55], v10 offset:2048
    ds_read_b64 v[88:89], v11 offset:1024
    v_mfma_f32_16x16x32_bf16 v[24:27], v[116:119], v[140:143], v[24:27]
    ds_read_b64 v[90:91], v11 offset:1032
    ds_read_b128 v[56:59], v10 offset:2560
    v_mfma_f32_16x16x32_bf16 v[16:19], v[100:103], v[148:151], v[16:19]
    ds_read_b64 v[92:93], v11 offset:512
    ds_read_b64 v[94:95], v11 offset:520
    v_mfma_f32_16x16x32_bf16 v[20:23], v[104:107], v[148:151], v[20:23]
    ds_read_b128 v[60:63], v10 offset:3072
    v_add_u32 v11, -64, v11
    v_add_u32 v10, -64, v10
    v_mfma_f32_16x16x32_bf16 v[24:27], v[108:111], v[148:151], v[24:27]
    v_mfma_f32_16x16x32_bf16 v[20:23], v[120:123], v[132:135], v[20:23]
    v_mfma_f32_16x16x32_bf16 v[24:27], v[120:123], v[136:139], v[24:27]
    v_mfma_f32_16x16x32_bf16 v[20:23], v[100:103], v[152:155], v[20:23]
    v_mfma_f32_16x16x32_bf16 v[24:27], v[104:107], v[152:155], v[24:27]
    v_mfma_f32_16x16x32_bf16 v[24:27], v[124:127], v[132:135], v[24:27]
    v_mfma_f32_16x16x32_bf16 v[24:27], v[100:103], v[156:159], v[24:27]
L_sv3:
    s_cmp_eq_u32 s99, 0
    s_cbranch_scc1 L_sv3_a
    s_waitcnt vmcnt(0)
    s_mov_b64 exec, 1
    ds_add_u32 v8, v9
    s_mov_b64 exec, -1
    v_add_u32 v8, 4, v8
    s_waitcnt lgkmcnt(0)
    s_add_u32 s98, s98, 1
    s_mov_b32 s99, 0
L_sv3_a:
    s_cmp_gt_u32 s98, 3
    s_cbranch_scc1 L_sv3_z
    ds_read_b32 v3, v8 offset:8
    s_waitcnt lgkmcnt(0)
    v_cmp_gt_u32 vcc, 8, v3
    s_cbranch_vccnz L_sv3_n
    s_getpc_b64 s[90:91]
    s_add_u32 s90, s90, 12
    s_addc_u32 s91, s91, 0
    s_branch L_stage_all
    s_mov_b32 s99, 1
L_sv3_n:
L_sv3_z:
    s_sub_u32 s96, s96, 1
    s_cmp_lg_u32 s96, 0
    s_cbranch_scc1 L_cvB
    s_waitcnt lgkmcnt(0)
    s_setprio 3
    v_lshrrev_b32 v2, 4, v0
    v_lshlrev_b32 v2, 7, v2
    v_and_b32 v3, 15, v0
    v_lshlrev_b32 v3, 2, v3
    v_add_u32 v2, v2, v3
    s_nop 3
    v_cvt_pk_bf16_f32 v60, v16, v17
    v_cvt_pk_bf16_f32 v61, v18, v19
    s_add_u32 s76, s75, s69
    s_mul_i32 s76, s76, 4352
    s_add_u32 s76, s76, 5767168
    buffer_store_dword v60, v2, s[56:59], s76 offen offset:2048 sc1
    buffer_store_dword v61, v2, s[56:59], s76 offen offset:2112 sc1
    v_cvt_pk_bf16_f32 v62, v20, v21
    v_cvt_pk_bf16_f32 v63, v22, v23
    buffer_store_dword v62, v2, s[56:59], s76 offen offset:2560 sc1
    buffer_store_dword v63, v2, s[56:59], s76 offen offset:2624 sc1
    v_cvt_pk_bf16_f32 v64, v24, v25
    v_cvt_pk_bf16_f32 v65, v26, v27
    buffer_store_dword v64, v2, s[56:59], s76 offen offset:3072 sc1
    buffer_store_dword v65, v2, s[56:59], s76 offen offset:3136 sc1
    s_branch L_B_sig
L_B_helper:
    s_lshr_b32 s84, s2, 3
    s_lshl_b32 s84, s84, 2
    s_add_u32 s84, s84, s69
    s_mul_i32 s84, s84, 6400
    v_lshlrev_b32 v2, 7, v0
    s_mov_b32 exec_hi, 0x3ffff
    buffer_load_dword v14, v2, s[48:51], s84 offen
    s_mov_b32 exec_hi, -1
    s_mul_i32 s84, s71, 81920
    s_mul_i32 s85, s72, 10240
    s_add_u32 s84, s84, s85
    s_mul_i32 s85, s69, 2560
    s_add_u32 s84, s84, s85
    s_add_u32 s84, s84, 3145728
    s_mov_b32 exec_hi, 0
    s_mov_b32 exec_lo, 0xfffff
    buffer_load_dword v14, v2, s[56:59], s84 offen
    s_mov_b64 exec, -1
    s_cmp_eq_u32 s74, 2
    s_cbranch_scc1 L_B_two_b
    s_mov_b32 s97, 0
    v_mov_b32 v2, 163340
L_spin7:
    ds_read_b32 v3, v2
    s_add_u32 s97, s97, 1
    s_cmp_gt_u32 s97, 0x1000000
    s_cbranch_scc1 L_spin7_done
    s_waitcnt lgkmcnt(0)
    v_cmp_gt_u32 vcc, 192, v3
    s_cbranch_vccz L_spin7_done
    s_sleep 1
    s_branch L_spin7
L_spin7_done:
    s_setprio 0
    ds_read_b64 v[64:65], v11 offset:3584
    ds_read_b64 v[66:67], v11 offset:3592
    ds_read_b128 v[52:55], v10 offset:0
    ds_read_b64 v[68:69], v11 offset:3072
    ds_read_b64 v[70:71], v11 offset:3080
    ds_read_b128 v[56:59], v10 offset:512
    ds_read_b64 v[72:73], v11 offset:2560
    ds_read_b64 v[74:75], v11 offset:2568
    ds_read_b128 v[60:63], v10 offset:1024
    s_mov_b32 s96, 4
L_cv7:
    s_waitcnt lgkmcnt(0)
    v_mfma_f32_16x16x32_bf16 v[16:19], v[52:55], v[64:67], v[16:19]
    ds_read_b64 v[88:89], v11 offset:21120
    ds_read_b64 v[90:91], v11 offset:21128
    ds_read_b128 v[76:79], v10 offset:17536
    v_mfma_f32_16x16x32_bf16 v[20:23], v[56:59], v[64:67], v[20:23]
    ds_read_b64 v[92:93], v11 offset:20608
    ds_read_b64 v[94:95], v11 offset:20616
    ds_read_b128 v[80:83], v10 offset:18048
    v_mfma_f32_16x16x32_bf16 v[24:27], v[60:63], v[64:67], v[24:27]
    ds_read_b64 v[96:97], v11 offset:20096
    ds_read_b64 v[98:99], v11 offset:20104
    ds_read_b128 v[84:87], v10 offset:18560
    v_mfma_f32_16x16x32_bf16 v[20:23], v[52:55], v[68:71], v[20:23]
    v_add_u32 v11, -64, v11
    v_add_u32 v10, -64, v10
    v_mfma_f32_16x16x32_bf16 v[24:27], v[56:59], v[68:71], v[24:27]
    v_mfma_f32_16x16x32_bf16 v[24:27], v[52:55], v[72:75], v[24:27]
    s_waitcnt lgkmcnt(0)
    v_mfma_f32_16x16x32_bf16 v[28:31], v[76:79], v[88:91], v[28:31]
    ds_read_b64 v[64:65], v13 offset:3584
    ds_read_b64 v[66:67], v13 offset:3592
    ds_read_b128 v[52:55], v12 offset:0
    v_mfma_f32_16x16x32_bf16 v[32:35], v[80:83], v[88:91], v[32:35]
    ds_read_b64 v[68:69], v13 offset:3072
    ds_read_b64 v[70:71], v13 offset:3080
    ds_read_b128 v[56:59], v12 offset:512
    v_mfma_f32_16x16x32_bf16 v[36:39], v[84:87], v[88:91], v[36:39]
    ds_read_b64 v[72:73], v13 offset:2560
    ds_read_b64 v[74:75], v13 offset:2568
    ds_read_b128 v[60:63], v12 offset:1024
    v_mfma_f32_16x16x32_bf16 v[32:35], v[76:79], v[92:95], v[32:35]
    v_add_u32 v12, -64, v12
    v_add_u32 v13, -64, v13
    v_mfma_f32_16x16x32_bf16 v[36:39], v[80:83], v[92:95], v[36:39]
    v_mfma_f32_16x16x32_bf16 v[36:39], v[76:79], v[96:99], v[36:39]
    s_waitcnt lgkmcnt(0)
    v_mfma_f32_16x16x32_bf16 v[40:43], v[52:55], v[64:67], v[40:43]
    ds_read_b64 v[88:89], v11 offset:3584
    ds_read_b64 v[90:91], v11 offset:3592
    ds_read_b128 v[76:79], v10 offset:0
    v_mfma_f32_16x16x32_bf16 v[44:47], v[56:59], v[64:67], v[44:47]
    ds_read_b64 v[92:93], v11 offset:3072
    ds_read_b64 v[94:95], v11 offset:3080
    ds_read_b128 v[80:83], v10 offset:512
    v_mfma_f32_16x16x32_bf16 v[48:51], v[60:63], v[64:67], v[48:51]
    ds_read_b64 v[96:97], v11 offset:2560
    ds_read_b64 v[98:99], v11 offset:2568
    ds_read_b128 v[84:87], v10 offset:1024
    v_mfma_f32_16x16x32_bf16 v[44:47], v[52:55], v[68:71], v[44:47]
    v_mfma_f32_16x16x32_bf16 v[48:51], v[56:59], v[68:71], v[48:51]
    v_mfma_f32_16x16x32_bf16 v[48:51], v[52:55], v[72:75], v[48:51]
L_sv4:
    s_cmp_eq_u32 s99, 0
    s_cbranch_scc1 L_sv4_a
    s_waitcnt vmcnt(0)
    s_mov_b64 exec, 1
    ds_add_u32 v8, v9
    s_mov_b64 exec, -1
    v_add_u32 v8, 4, v8
    s_waitcnt lgkmcnt(0)
    s_add_u32 s98, s98, 1
    s_mov_b32 s99, 0
L_sv4_a:
    s_cmp_gt_u32 s98, 3
    s_cbranch_scc1 L_sv4_z
    ds_read_b32 v3, v8 offset:8
    s_waitcnt lgkmcnt(0)
    v_cmp_gt_u32 vcc, 8, v3
    s_cbranch_vccnz L_sv4_n
    s_getpc_b64 s[90:91]
    s_add_u32 s90, s90, 12
    s_addc_u32 s91, s91, 0
    s_branch L_stage_all
    s_mov_b32 s99, 1
L_sv4_n:
L_sv4_z:
    s_waitcnt lgkmcnt(0)
    v_mfma_f32_16x16x32_bf16 v[16:19], v[76:79], v[88:91], v[16:19]
    ds_read_b64 v[64:65], v11 offset:21120
    ds_read_b64 v[66:67], v11 offset:21128
    ds_read_b128 v[52:55], v10 offset:17536
    v_mfma_f32_16x16x32_bf16 v[20:23], v[80:83], v[88:91], v[20:23]
    ds_read_b64 v[68:69], v11 offset:20608
    ds_read_b64 v[70:71], v11 offset:20616
    ds_read_b128 v[56:59], v10 offset:18048
    v_mfma_f32_16x16x32_bf16 v[24:27], v[84:87], v[88:91], v[24:27]
    ds_read_b64 v[72:73], v11 offset:20096
    ds_read_b64 v[74:75], v11 offset:20104
    ds_read_b128 v[60:63], v10 offset:18560
    v_mfma_f32_16x16x32_bf16 v[20:23], v[76:79], v[92:95], v[20:23]
    v_add_u32 v11, -64, v11
    v_add_u32 v10, -64, v10
    v_mfma_f32_16x16x32_bf16 v[24:27], v[80:83], v[92:95], v[24:27]
    v_mfma_f32_16x16x32_bf16 v[24:27], v[76:79], v[96:99], v[24:27]
    s_waitcnt lgkmcnt(0)
    v_mfma_f32_16x16x32_bf16 v[28:31], v[52:55], v[64:67], v[28:31]
    ds_read_b64 v[88:89], v13 offset:3584
    ds_read_b64 v[90:91], v13 offset:3592
    ds_read_b128 v[76:79], v12 offset:0
    v_mfma_f32_16x16x32_bf16 v[32:35], v[56:59], v[64:67], v[32:35]
    ds_read_b64 v[92:93], v13 offset:3072
    ds_read_b64 v[94:95], v13 offset:3080
    ds_read_b128 v[80:83], v12 offset:512
    v_mfma_f32_16x16x32_bf16 v[36:39], v[60:63], v[64:67], v[36:39]
    ds_read_b64 v[96:97], v13 offset:2560
    ds_read_b64 v[98:99], v13 offset:2568
    ds_read_b128 v[84:87], v12 offset:1024
    v_mfma_f32_16x16x32_bf16 v[32:35], v[52:55], v[68:71], v[32:35]
    v_add_u32 v12, -64, v12
    v_add_u32 v13, -64, v13
    v_mfma_f32_16x16x32_bf16 v[36:39], v[56:59], v[68:71], v[36:39]
    v_mfma_f32_16x16x32_bf16 v[36:39], v[52:55], v[72:75], v[36:39]
    s_waitcnt lgkmcnt(0)
    v_mfma_f32_16x16x32_bf16 v[40:43], v[76:79], v[88:91], v[40:43]
    ds_read_b64 v[64:65], v11 offset:3584
    ds_read_b64 v[66:67], v11 offset:3592
    ds_read_b128 v[52:55], v10 offset:0
    v_mfma_f32_16x16x32_bf16 v[44:47], v[80:83], v[88:91], v[44:47]
    ds_read_b64 v[68:69], v11 offset:3072
    ds_read_b64 v[70:71], v11 offset:3080
    ds_read_b128 v[56:59], v10 offset:512
    v_mfma_f32_16x16x32_bf16 v[48:51], v[84:87], v[88:91], v[48:51]
    ds_read_b64 v[72:73], v11 offset:2560
    ds_read_b64 v[74:75], v11 offset:2568
    ds_read_b128 v[60:63], v10 offset:1024
    v_mfma_f32_16x16x32_bf16 v[44:47], v[76:79], v[92:95], v[44:47]
    v_mfma_f32_16x16x32_bf16 v[48:51], v[80:83], v[92:95], v[48:51]
    v_mfma_f32_16x16x32_bf16 v[48:51], v[76:79], v[96:99], v[48:51]
L_sv5:
    s_cmp_eq_u32 s99, 0
    s_cbranch_scc1 L_sv5_a
    s_waitcnt vmcnt(0)
    s_mov_b64 exec, 1
    ds_add_u32 v8, v9
    s_mov_b64 exec, -1
    v_add_u32 v8, 4, v8
    s_waitcnt lgkmcnt(0)
    s_add_u32 s98, s98, 1
    s_mov_b32 s99, 0
L_sv5_a:
    s_cmp_gt_u32 s98, 3
    s_cbranch_scc1 L_sv5_z
    ds_read_b32 v3, v8 offset:8
    s_waitcnt lgkmcnt(0)
    v_cmp_gt_u32 vcc, 8, v3
    s_cbranch_vccnz L_sv5_n
    s_getpc_b64 s[90:91]
    s_add_u32 s90, s90, 12
    s_addc_u32 s91, s91, 0
    s_branch L_stage_all
    s_mov_b32 s99, 1
L_sv5_n:
L_sv5_z:
    s_sub_u32 s96, s96, 1
    s_cmp_lg_u32 s96, 0
    s_cbranch_scc1 L_cv7
    s_waitcnt lgkmcnt(0)
    s_setprio 3
    v_lshrrev_b32 v2, 4, v0
    v_lshlrev_b32 v2, 7, v2
    v_and_b32 v3, 15, v0
    v_lshlrev_b32 v3, 2, v3
    v_add_u32 v2, v2, v3
    s_nop 3
    v_cvt_pk_bf16_f32 v60, v16, v17
    v_cvt_pk_bf16_f32 v61, v18, v19
    s_add_u32 s76, s75, 0
    s_mul_i32 s76, s76, 4352
    s_add_u32 s76, s76, 5767168
    buffer_store_dword v60, v2, s[56:59], s76 offen offset:0 sc1
    buffer_store_dword v61, v2, s[56:59], s76 offen offset:64 sc1
    v_cvt_pk_bf16_f32 v62, v20, v21
    v_cvt_pk_bf16_f32 v63, v22, v23
    buffer_store_dword v62, v2, s[56:59], s76 offen offset:512 sc1
    buffer_store_dword v63, v2, s[56:59], s76 offen offset:576 sc1
    v_cvt_pk_bf16_f32 v64, v24, v25
    v_cvt_pk_bf16_f32 v65, v26, v27
    buffer_store_dword v64, v2, s[56:59], s76 offen offset:1024 sc1
    buffer_store_dword v65, v2, s[56:59], s76 offen offset:1088 sc1
    v_cvt_pk_bf16_f32 v66, v28, v29
    v_cvt_pk_bf16_f32 v67, v30, v31
    s_add_u32 s76, s75, 1
    s_mul_i32 s76, s76, 4352
    s_add_u32 s76, s76, 5767168
    buffer_store_dword v66, v2, s[56:59], s76 offen offset:0 sc1
    buffer_store_dword v67, v2, s[56:59], s76 offen offset:64 sc1
    v_cvt_pk_bf16_f32 v68, v32, v33
    v_cvt_pk_bf16_f32 v69, v34, v35
    buffer_store_dword v68, v2, s[56:59], s76 offen offset:512 sc1
    buffer_store_dword v69, v2, s[56:59], s76 offen offset:576 sc1
    v_cvt_pk_bf16_f32 v70, v36, v37
    v_cvt_pk_bf16_f32 v71, v38, v39
    buffer_store_dword v70, v2, s[56:59], s76 offen offset:1024 sc1
    buffer_store_dword v71, v2, s[56:59], s76 offen offset:1088 sc1
    v_cvt_pk_bf16_f32 v72, v40, v41
    v_cvt_pk_bf16_f32 v73, v42, v43
    s_add_u32 s76, s75, 2
    s_mul_i32 s76, s76, 4352
    s_add_u32 s76, s76, 5767168
    buffer_store_dword v72, v2, s[56:59], s76 offen offset:0 sc1
    buffer_store_dword v73, v2, s[56:59], s76 offen offset:64 sc1
    v_cvt_pk_bf16_f32 v74, v44, v45
    v_cvt_pk_bf16_f32 v75, v46, v47
    buffer_store_dword v74, v2, s[56:59], s76 offen offset:512 sc1
    buffer_store_dword v75, v2, s[56:59], s76 offen offset:576 sc1
    v_cvt_pk_bf16_f32 v76, v48, v49
    v_cvt_pk_bf16_f32 v77, v50, v51
    buffer_store_dword v76, v2, s[56:59], s76 offen offset:1024 sc1
    buffer_store_dword v77, v2, s[56:59], s76 offen offset:1088 sc1
    s_branch L_B_sig
L_B_two_b:
    s_mov_b32 s97, 0
    v_mov_b32 v2, 163340
L_spin7b:
    ds_read_b32 v3, v2
    s_add_u32 s97, s97, 1
    s_cmp_gt_u32 s97, 0x1000000
    s_cbranch_scc1 L_spin7b_done
    s_waitcnt lgkmcnt(0)
    v_cmp_gt_u32 vcc, 128, v3
    s_cbranch_vccz L_spin7b_done
    s_sleep 1
    s_branch L_spin7b
L_spin7b_done:
    s_setprio 0
    ds_read_b64 v[68:69], v11 offset:3584
    ds_read_b64 v[70:71], v11 offset:3592
    ds_read_b128 v[36:39], v10 offset:0
    ds_read_b64 v[72:73], v11 offset:3072
    ds_read_b64 v[74:75], v11 offset:3080
    ds_read_b128 v[40:43], v10 offset:512
    ds_read_b64 v[76:77], v11 offset:2560
    ds_read_b64 v[78:79], v11 offset:2568
    ds_read_b128 v[44:47], v10 offset:1024
    ds_read_b64 v[80:81], v11 offset:2048
    ds_read_b64 v[82:83], v11 offset:2056
    ds_read_b128 v[48:51], v10 offset:1536
    ds_read_b64 v[84:85], v11 offset:1536
    ds_read_b64 v[86:87], v11 offset:1544
    ds_read_b128 v[52:55], v10 offset:2048
    ds_read_b64 v[88:89], v11 offset:1024
    ds_read_b64 v[90:91], v11 offset:1032
    ds_read_b128 v[56:59], v10 offset:2560
    ds_read_b64 v[92:93], v11 offset:512
    ds_read_b64 v[94:95], v11 offset:520
    ds_read_b128 v[60:63], v10 offset:3072
    ds_read_b64 v[96:97], v11 offset:0
    ds_read_b64 v[98:99], v11 offset:8
    ds_read_b128 v[64:67], v10 offset:3584
    v_add_u32 v11, -64, v11
    v_add_u32 v10, -64, v10
    s_mov_b32 s96, 4
L_cvC:
    s_waitcnt lgkmcnt(0)
    v_mfma_f32_16x16x32_bf16 v[16:19], v[36:39], v[68:71], v[16:19]
    ds_read_b64 v[132:133], v11 offset:3584
    ds_read_b64 v[134:135], v11 offset:3592
    v_mfma_f32_16x16x32_bf16 v[20:23], v[40:43], v[68:71], v[20:23]
    ds_read_b128 v[100:103], v10 offset:0
    ds_read_b64 v[136:137], v11 offset:3072
    v_mfma_f32_16x16x32_bf16 v[20:23], v[36:39], v[72:75], v[20:23]
    ds_read_b64 v[138:139], v11 offset:3080
    ds_read_b128 v[104:107], v10 offset:512
    v_mfma_f32_16x16x32_bf16 v[24:27], v[40:43], v[72:75], v[24:27]
    ds_read_b64 v[140:141], v11 offset:2560
    ds_read_b64 v[142:143], v11 offset:2568
    v_mfma_f32_16x16x32_bf16 v[24:27], v[44:47], v[68:71], v[24:27]
    ds_read_b128 v[108:111], v10 offset:1024
    ds_read_b64 v[144:145], v11 offset:2048
    v_mfma_f32_16x16x32_bf16 v[28:31], v[44:47], v[72:75], v[28:31]
    ds_read_b64 v[146:147], v11 offset:2056
    ds_read_b128 v[112:115], v10 offset:1536
    v_mfma_f32_16x16x32_bf16 v[24:27], v[36:39], v[76:79], v[24:27]
    ds_read_b64 v[148:149], v11 offset:1536
    ds_read_b64 v[150:151], v11 offset:1544
    v_mfma_f32_16x16x32_bf16 v[28:31], v[40:43], v[76:79], v[28:31]
    ds_read_b128 v[116:119], v10 offset:2048
    ds_read_b64 v[152:153], v11 offset:1024
    v_mfma_f32_16x16x32_bf16 v[28:31], v[48:51], v[68:71], v[28:31]
    ds_read_b64 v[154:155], v11 offset:1032
    ds_read_b128 v[120:123], v10 offset:2560
    v_mfma_f32_16x16x32_bf16 v[28:31], v[36:39], v[80:83], v[28:31]
    ds_read_b64 v[156:157], v11 offset:512
    ds_read_b64 v[158:159], v11 offset:520
    v_mfma_f32_16x16x32_bf16 v[32:35], v[52:55], v[80:83], v[32:35]
    ds_read_b128 v[124:127], v10 offset:3072
    ds_read_b64 v[160:161], v11 offset:0
    v_mfma_f32_16x16x32_bf16 v[32:35], v[48:51], v[84:87], v[32:35]
    ds_read_b64 v[162:163], v11 offset:8
    ds_read_b128 v[128:131], v10 offset:3584
    v_mfma_f32_16x16x32_bf16 v[32:35], v[56:59], v[76:79], v[32:35]
    v_add_u32 v11, -64, v11
    v_add_u32 v10, -64, v10
    v_mfma_f32_16x16x32_bf16 v[32:35], v[44:47], v[88:91], v[32:35]
    v_mfma_f32_16x16x32_bf16 v[32:35], v[60:63], v[72:75], v[32:35]
    v_mfma_f32_16x16x32_bf16 v[32:35], v[40:43], v[92:95], v[32:35]
    v_mfma_f32_16x16x32_bf16 v[32:35], v[64:67], v[68:71], v[32:35]
    v_mfma_f32_16x16x32_bf16 v[32:35], v[36:39], v[96:99], v[32:35]
L_sv6:
    s_cmp_eq_u32 s99, 0
    s_cbranch_scc1 L_sv6_a
    s_waitcnt vmcnt(0)
    s_mov_b64 exec, 1
    ds_add_u32 v8, v9
    s_mov_b64 exec, -1
    v_add_u32 v8, 4, v8
    s_waitcnt lgkmcnt(0)
    s_add_u32 s98, s98, 1
    s_mov_b32 s99, 0
L_sv6_a:
    s_cmp_gt_u32 s98, 3
    s_cbranch_scc1 L_sv6_z
    ds_read_b32 v3, v8 offset:8
    s_waitcnt lgkmcnt(0)
    v_cmp_gt_u32 vcc, 8, v3
    s_cbranch_vccnz L_sv6_n
    s_getpc_b64 s[90:91]
    s_add_u32 s90, s90, 12
    s_addc_u32 s91, s91, 0
    s_branch L_stage_all
    s_mov_b32 s99, 1
L_sv6_n:
L_sv6_z:
    s_waitcnt lgkmcnt(0)
    v_mfma_f32_16x16x32_bf16 v[16:19], v[100:103], v[132:135], v[16:19]
    ds_read_b64 v[68:69], v11 offset:3584
    ds_read_b64 v[70:71], v11 offset:3592
    v_mfma_f32_16x16x32_bf16 v[20:23], v[104:107], v[132:135], v[20:23]
    ds_read_b128 v[36:39], v10 offset:0
    ds_read_b64 v[72:73], v11 offset:3072
    v_mfma_f32_16x16x32_bf16 v[20:23], v[100:103], v[136:139], v[20:23]
    ds_read_b64 v[74:75], v11 offset:3080
    ds_read_b128 v[40:43], v10 offset:512
    v_mfma_f32_16x16x32_bf16 v[24:27], v[104:107], v[136:139], v[24:27]
    ds_read_b64 v[76:77], v11 offset:2560
    ds_read_b64 v[78:79], v11 offset:2568
    v_mfma_f32_16x16x32_bf16 v[24:27], v[108:111], v[132:135], v[24:27]
    ds_read_b128 v[44:47], v10 offset:1024
    ds_read_b64 v[80:81], v11 offset:2048
    v_mfma_f32_16x16x32_bf16 v[28:31], v[108:111], v[136:139], v[28:31]
    ds_read_b64 v[82:83], v11 offset:2056
    ds_read_b128 v[48:51], v10 offset:1536
    v_mfma_f32_16x16x32_bf16 v[24:27], v[100:103], v[140:143], v[24:27]
    ds_read_b64 v[84:85], v11 offset:1536
    ds_read_b64 v[86:87], v11 offset:1544
    v_mfma_f32_16x16x32_bf16 v[28:31], v[104:107], v[140:143], v[28:31]
    ds_read_b128 v[52:55], v10 offset:2048
    ds_read_b64 v[88:89], v11 offset:1024
    v_mfma_f32_16x16x32_bf16 v[28:31], v[112:115], v[132:135], v[28:31]
    ds_read_b64 v[90:91], v11 offset:1032
    ds_read_b128 v[56:59], v10 offset:2560
    v_mfma_f32_16x16x32_bf16 v[28:31], v[100:103], v[144:147], v[28:31]
    ds_read_b64 v[92:93], v11 offset:512
    ds_read_b64 v[94:95], v11 offset:520
    v_mfma_f32_16x16x32_bf16 v[32:35], v[116:119], v[144:147], v[32:35]
    ds_read_b128 v[60:63], v10 offset:3072
    ds_read_b64 v[96:97], v11 offset:0
    v_mfma_f32_16x16x32_bf16 v[32:35], v[112:115], v[148:151], v[32:35]
    ds_read_b64 v[98:99], v11 offset:8
    ds_read_b128 v[64:67], v10 offset:3584
    v_mfma_f32_16x16x32_bf16 v[32:35], v[120:123], v[140:143], v[32:35]
    v_add_u32 v11, -64, v11
    v_add_u32 v10, -64, v10
    v_mfma_f32_16x16x32_bf16 v[32:35], v[108:111], v[152:155], v[32:35]
    v_mfma_f32_16x16x32_bf16 v[32:35], v[124:127], v[136:139], v[32:35]
    v_mfma_f32_16x16x32_bf16 v[32:35], v[104:107], v[156:159], v[32:35]
    v_mfma_f32_16x16x32_bf16 v[32:35], v[128:131], v[132:135], v[32:35]
    v_mfma_f32_16x16x32_bf16 v[32:35], v[100:103], v[160:163], v[32:35]
L_sv7:
    s_cmp_eq_u32 s99, 0
    s_cbranch_scc1 L_sv7_a
    s_waitcnt vmcnt(0)
    s_mov_b64 exec, 1
    ds_add_u32 v8, v9
    s_mov_b64 exec, -1
    v_add_u32 v8, 4, v8
    s_waitcnt lgkmcnt(0)
    s_add_u32 s98, s98, 1
    s_mov_b32 s99, 0
L_sv7_a:
    s_cmp_gt_u32 s98, 3
    s_cbranch_scc1 L_sv7_z
    ds_read_b32 v3, v8 offset:8
    s_waitcnt lgkmcnt(0)
    v_cmp_gt_u32 vcc, 8, v3
    s_cbranch_vccnz L_sv7_n
    s_getpc_b64 s[90:91]
    s_add_u32 s90, s90, 12
    s_addc_u32 s91, s91, 0
    s_branch L_stage_all
    s_mov_b32 s99, 1
L_sv7_n:
L_sv7_z:
    s_sub_u32 s96, s96, 1
    s_cmp_lg_u32 s96, 0
    s_cbranch_scc1 L_cvC
    s_waitcnt lgkmcnt(0)
    s_setprio 3
    s_and_b32 s82, s69, 1
    v_lshrrev_b32 v2, 4, v0
    v_lshlrev_b32 v2, 7, v2
    v_and_b32 v3, 15, v0
    v_lshlrev_b32 v3, 2, v3
    v_add_u32 v2, v2, v3
    s_nop 3
    v_cvt_pk_bf16_f32 v60, v16, v17
    v_cvt_pk_bf16_f32 v61, v18, v19
    s_add_u32 s76, s75, s82
    s_mul_i32 s76, s76, 4352
    s_add_u32 s76, s76, 5767168
    buffer_store_dword v60, v2, s[56:59], s76 offen offset:0 sc1
    buffer_store_dword v61, v2, s[56:59], s76 offen offset:64 sc1
    v_cvt_pk_bf16_f32 v62, v20, v21
    v_cvt_pk_bf16_f32 v63, v22, v23
    buffer_store_dword v62, v2, s[56:59], s76 offen offset:512 sc1
    buffer_store_dword v63, v2, s[56:59], s76 offen offset:576 sc1
    v_cvt_pk_bf16_f32 v64, v24, v25
    v_cvt_pk_bf16_f32 v65, v26, v27
    buffer_store_dword v64, v2, s[56:59], s76 offen offset:1024 sc1
    buffer_store_dword v65, v2, s[56:59], s76 offen offset:1088 sc1
    v_cvt_pk_bf16_f32 v66, v28, v29
    v_cvt_pk_bf16_f32 v67, v30, v31
    buffer_store_dword v66, v2, s[56:59], s76 offen offset:1536 sc1
    buffer_store_dword v67, v2, s[56:59], s76 offen offset:1600 sc1
    v_cvt_pk_bf16_f32 v68, v32, v33
    v_cvt_pk_bf16_f32 v69, v34, v35
    buffer_store_dword v68, v2, s[56:59], s76 offen offset:3584 sc1
    buffer_store_dword v69, v2, s[56:59], s76 offen offset:3648 sc1
L_B_sig:
    s_waitcnt vmcnt(0)
    v_mov_b32 v2, 163336
    v_mov_b32 v3, 1
    s_mov_b64 exec, 1
    ds_add_rtn_u32 v4, v2, v3
    s_waitcnt lgkmcnt(0)
    v_readfirstlane_b32 s76, v4
    s_nop 1
    s_cmp_lg_u32 s76, 3
    s_cbranch_scc1 L_noysig
    s_lshl_b32 s76, s2, 7
    s_add_u32 s76, s76, 8192
    v_mov_b32 v2, 0
    v_mov_b32 v3, s3
    buffer_store_dword v3, v2, s[56:59], s76 offen sc1
L_noysig:
    s_mov_b64 exec, -1
    s_mov_b32 s97, 0
L_sv8:
    s_cmp_eq_u32 s99, 0
    s_cbranch_scc1 L_sv8_a
    s_waitcnt vmcnt(0)
    s_mov_b64 exec, 1
    ds_add_u32 v8, v9
    s_mov_b64 exec, -1
    v_add_u32 v8, 4, v8
    s_waitcnt lgkmcnt(0)
    s_add_u32 s98, s98, 1
    s_mov_b32 s99, 0
L_sv8_a:
    s_cmp_gt_u32 s98, 3
    s_cbranch_scc1 L_sv8_z
    ds_read_b32 v3, v8 offset:8
    s_waitcnt lgkmcnt(0)
    v_cmp_gt_u32 vcc, 8, v3
    s_cbranch_vccnz L_sv8_n
    s_getpc_b64 s[90:91]
    s_add_u32 s90, s90, 12
    s_addc_u32 s91, s91, 0
    s_branch L_stage_all
    s_mov_b32 s99, 1
L_sv8_n:
    s_add_u32 s97, s97, 1
    s_cmp_gt_u32 s97, 0x1000000
    s_cbranch_scc1 L_sv8_z
    s_sleep 8
    s_branch L_sv8
L_sv8_z:
    s_mov_b32 s97, 0
    v_mov_b32 v2, 163336
L_spin8:
    ds_read_b32 v3, v2
    s_add_u32 s97, s97, 1
    s_cmp_gt_u32 s97, 0x1000000
    s_cbranch_scc1 L_spin8_done
    s_waitcnt lgkmcnt(0)
    v_cmp_gt_u32 vcc, 4, v3
    s_cbranch_vccz L_spin8_done
    s_sleep 8
    s_branch L_spin8
L_spin8_done:
L_B_wo:
    v_add_u32 v2, 0, v0
    v_mul_u32_u24 v3, 0x199a, v2
    v_lshrrev_b32 v3, 16, v3
    v_mul_u32_u24 v4, 10, v3
    v_sub_u32 v4, v2, v4
    v_lshlrev_b32 v4, 4, v4
    v_mul_u32_u24 v3, 1280, v3
    v_add_u32 v161, v3, v4
    v_add_u32 v2, 64, v0
    v_mul_u32_u24 v3, 0x199a, v2
    v_lshrrev_b32 v3, 16, v3
    v_mul_u32_u24 v4, 10, v3
    v_sub_u32 v4, v2, v4
    v_lshlrev_b32 v4, 4, v4
    v_mul_u32_u24 v3, 1280, v3
    v_add_u32 v162, v3, v4
    v_add_u32 v2, 128, v0
    v_mul_u32_u24 v3, 0x199a, v2
    v_lshrrev_b32 v3, 16, v3
    v_mul_u32_u24 v4, 10, v3
    v_sub_u32 v4, v2, v4
    v_lshlrev_b32 v4, 4, v4
    v_mul_u32_u24 v3, 1280, v3
    v_add_u32 v163, v3, v4
    v_add_u32 v2, 192, v0
    v_mul_u32_u24 v3, 0x199a, v2
    v_lshrrev_b32 v3, 16, v3
    v_mul_u32_u24 v4, 10, v3
    v_sub_u32 v4, v2, v4
    v_lshlrev_b32 v4, 4, v4
    v_mul_u32_u24 v3, 1280, v3
    v_add_u32 v164, v3, v4
    v_add_u32 v2, 256, v0
    v_mul_u32_u24 v3, 0x199a, v2
    v_lshrrev_b32 v3, 16, v3
    v_mul_u32_u24 v4, 10, v3
    v_sub_u32 v4, v2, v4
    v_lshlrev_b32 v4, 4, v4
    v_mul_u32_u24 v3, 1280, v3
    v_add_u32 v165, v3, v4
    s_mov_b32 s78, 4
    s_cmp_eq_u32 s69, 1
    s_cselect_b32 s78, 5, s78
    s_cmp_eq_u32 s69, 2
    s_cselect_b32 s78, 6, s78
    s_cmp_eq_u32 s69, 3
    s_cselect_b32 s78, 7, s78
    s_mov_b32 s79, 43008
    s_cmp_eq_u32 s69, 1
    s_cselect_b32 s79, 48128, s79
    s_cmp_eq_u32 s69, 2
    s_cselect_b32 s79, 53248, s79
    s_cmp_eq_u32 s69, 3
    s_cselect_b32 s79, 58368, s79
    s_mul_i32 s84, s78, 40960
    s_mul_i32 s85, s72, 160
    s_add_u32 s84, s84, s85
    s_add_u32 m0, s79, 0
    s_nop 0
    buffer_load_dwordx4 v161, s[48:51], s84 offen lds
    s_add_u32 m0, s79, 1024
    s_nop 0
    buffer_load_dwordx4 v162, s[48:51], s84 offen lds
    s_add_u32 m0, s79, 2048
    s_nop 0
    buffer_load_dwordx4 v163, s[48:51], s84 offen lds
    s_add_u32 m0, s79, 3072
    s_nop 0
    buffer_load_dwordx4 v164, s[48:51], s84 offen lds
    s_add_u32 m0, s79, 4096
    s_nop 0
    buffer_load_dwordx4 v165, s[48:51], s84 offen lds
    s_mov_b32 s78, 14
    s_cmp_eq_u32 s69, 1
    s_cselect_b32 s78, 15, s78
    s_cmp_eq_u32 s69, 2
    s_cselect_b32 s78, 16, s78
    s_cmp_eq_u32 s69, 3
    s_cselect_b32 s78, 17, s78
    s_mov_b32 s79, 73728
    s_cmp_eq_u32 s69, 1
    s_cselect_b32 s79, 124928, s79
    s_cmp_eq_u32 s69, 2
    s_cselect_b32 s79, 130048, s79
    s_cmp_eq_u32 s69, 3
    s_cselect_b32 s79, 135168, s79
    s_mul_i32 s84, s78, 40960
    s_mul_i32 s85, s72, 160
    s_add_u32 s84, s84, s85
    s_add_u32 m0, s79, 0
    s_nop 0
    buffer_load_dwordx4 v161, s[48:51], s84 offen lds
    s_add_u32 m0, s79, 1024
    s_nop 0
    buffer_load_dwordx4 v162, s[48:51], s84 offen lds
    s_add_u32 m0, s79, 2048
    s_nop 0
    buffer_load_dwordx4 v163, s[48:51], s84 offen lds
    s_add_u32 m0, s79, 3072
    s_nop 0
    buffer_load_dwordx4 v164, s[48:51], s84 offen lds
    s_add_u32 m0, s79, 4096
    s_nop 0
    buffer_load_dwordx4 v165, s[48:51], s84 offen lds
    s_mov_b32 s78, 8
    s_cmp_eq_u32 s69, 1
    s_cselect_b32 s78, 9, s78
    s_cmp_eq_u32 s69, 2
    s_cselect_b32 s78, 18, s78
    s_cmp_eq_u32 s69, 3
    s_cselect_b32 s78, 19, s78
    s_mov_b32 s79, 63488
    s_cmp_eq_u32 s69, 1
    s_cselect_b32 s79, 68608, s79
    s_cmp_eq_u32 s69, 2
    s_cselect_b32 s79, 140288, s79
    s_cmp_eq_u32 s69, 3
    s_cselect_b32 s79, 145408, s79
    s_mul_i32 s84, s78, 40960
    s_mul_i32 s85, s72, 160
    s_add_u32 s84, s84, s85
    s_add_u32 m0, s79, 0
    s_nop 0
    buffer_load_dwordx4 v161, s[48:51], s84 offen lds
    s_add_u32 m0, s79, 1024
    s_nop 0
    buffer_load_dwordx4 v162, s[48:51], s84 offen lds
    s_add_u32 m0, s79, 2048
    s_nop 0
    buffer_load_dwordx4 v163, s[48:51], s84 offen lds
    s_add_u32 m0, s79, 3072
    s_nop 0
    buffer_load_dwordx4 v164, s[48:51], s84 offen lds
    s_add_u32 m0, s79, 4096
    s_nop 0
    buffer_load_dwordx4 v165, s[48:51], s84 offen lds
    s_mov_b32 s97, 0
    v_mov_b32 v2, 163448
L_spin9:
    ds_read_b32 v3, v2
    s_add_u32 s97, s97, 1
    s_cmp_gt_u32 s97, 0x1000000
    s_cbranch_scc1 L_spin9_done
    s_waitcnt lgkmcnt(0)
    v_cmp_gt_u32 vcc, 8, v3
    s_cbranch_vccz L_spin9_done
    s_sleep 8
    s_branch L_spin9
L_spin9_done:
    s_mov_b32 s78, 0
    s_cmp_eq_u32 s69, 1
    s_cselect_b32 s78, 1, s78
    s_cmp_eq_u32 s69, 2
    s_cselect_b32 s78, 2, s78
    s_cmp_eq_u32 s69, 3
    s_cselect_b32 s78, 3, s78
    s_mov_b32 s79, 81920
    s_cmp_eq_u32 s69, 1
    s_cselect_b32 s79, 87040, s79
    s_cmp_eq_u32 s69, 2
    s_cselect_b32 s79, 92160, s79
    s_cmp_eq_u32 s69, 3
    s_cselect_b32 s79, 97280, s79
    s_mul_i32 s84, s78, 40960
    s_mul_i32 s85, s72, 160
    s_add_u32 s84, s84, s85
    s_add_u32 m0, s79, 0
    s_nop 0
    buffer_load_dwordx4 v161, s[48:51], s84 offen lds
    s_add_u32 m0, s79, 1024
    s_nop 0
    buffer_load_dwordx4 v162, s[48:51], s84 offen lds
    s_add_u32 m0, s79, 2048
    s_nop 0
    buffer_load_dwordx4 v163, s[48:51], s84 offen lds
    s_add_u32 m0, s79, 3072
    s_nop 0
    buffer_load_dwordx4 v164, s[48:51], s84 offen lds
    s_add_u32 m0, s79, 4096
    s_nop 0
    buffer_load_dwordx4 v165, s[48:51], s84 offen lds
    s_mov_b32 s78, 10
    s_cmp_eq_u32 s69, 1
    s_cselect_b32 s78, 11, s78
    s_cmp_eq_u32 s69, 2
    s_cselect_b32 s78, 12, s78
    s_cmp_eq_u32 s69, 3
    s_cselect_b32 s78, 13, s78
    s_mov_b32 s79, 102400
    s_cmp_eq_u32 s69, 1
    s_cselect_b32 s79, 107520, s79
    s_cmp_eq_u32 s69, 2
    s_cselect_b32 s79, 112640, s79
    s_cmp_eq_u32 s69, 3
    s_cselect_b32 s79, 117760, s79
    s_mul_i32 s84, s78, 40960
    s_mul_i32 s85, s72, 160
    s_add_u32 s84, s84, s85
    s_add_u32 m0, s79, 0
    s_nop 0
    buffer_load_dwordx4 v161, s[48:51], s84 offen lds
    s_add_u32 m0, s79, 1024
    s_nop 0
    buffer_load_dwordx4 v162, s[48:51], s84 offen lds
    s_add_u32 m0, s79, 2048
    s_nop 0
    buffer_load_dwordx4 v163, s[48:51], s84 offen lds
    s_add_u32 m0, s79, 3072
    s_nop 0
    buffer_load_dwordx4 v164, s[48:51], s84 offen lds
    s_add_u32 m0, s79, 4096
    s_nop 0
    buffer_load_dwordx4 v165, s[48:51], s84 offen lds
    s_cmp_lg_u32 s69, 0
    s_cbranch_scc1 L_y_wait
    s_lshl_b32 s76, s72, 5
    v_add_u32 v2, s76, v0
    v_lshlrev_b32 v2, 7, v2
    s_mov_b32 s78, 8192
    s_mov_b32 s97, 0
    s_mov_b32 exec_hi, 0
L_poll3:
    buffer_load_dword v3, v2, s[56:59], s78 offen sc1
    s_add_u32 s97, s97, 1
    s_cmp_gt_u32 s97, 0x40000
    s_cbranch_scc1 L_poll3_done
    s_waitcnt vmcnt(0)
    v_cmp_ne_u32 vcc, s3, v3
    s_cbranch_vccz L_poll3_done
    s_sleep 8
    s_branch L_poll3
L_poll3_done:
    s_mov_b32 exec_hi, -1
    v_mov_b32 v2, 163344
    v_mov_b32 v3, 1
    ds_write_b32 v2, v3
    s_branch L_y_go
L_y_wait:
    s_mov_b32 s97, 0
    v_mov_b32 v2, 163344
L_spin3:
    ds_read_b32 v3, v2
    s_add_u32 s97, s97, 1
    s_cmp_gt_u32 s97, 0x1000000
    s_cbranch_scc1 L_spin3_done
    s_waitcnt lgkmcnt(0)
    v_cmp_gt_u32 vcc, 1, v3
    s_cbranch_vccz L_spin3_done
    s_sleep 8
    s_branch L_spin3
L_spin3_done:
L_y_go:
    s_mul_i32 s76, s72, 348160
    s_lshl_b32 s77, s71, 7
    s_add_u32 s76, s76, s77
    s_lshl_b32 s77, s69, 5
    s_add_u32 s76, s76, s77
    s_add_u32 s76, s76, 5767168
    s_mul_i32 s77, s69, 2560
    s_add_u32 s77, s77, 150528
    v_lshrrev_b32 v2, 1, v0
    v_mul_u32_u24 v2, 4352, v2
    v_and_b32 v3, 1, v0
    v_lshlrev_b32 v3, 4, v3
    v_add_u32 v2, v2, v3
    s_add_u32 m0, s77, 0
    s_add_u32 s78, s76, 0
    buffer_load_dwordx4 v2, s[56:59], s78 offen sc1 lds
    s_add_u32 m0, s77, 1024
    s_add_u32 s78, s76, 139264
    buffer_load_dwordx4 v2, s[56:59], s78 offen sc1 lds
    s_mov_b32 exec_hi, 0
    s_add_u32 m0, s77, 2048
    s_add_u32 s78, s76, 278528
    buffer_load_dwordx4 v2, s[56:59], s78 offen sc1 lds
    s_mov_b32 exec_hi, -1
    v_lshrrev_b32 v2, 2, v0
    v_lshlrev_b32 v2, 5, v2
    v_and_b32 v3, 3, v0
    v_lshlrev_b32 v3, 3, v3
    v_add3_u32 v4, v2, v3, s77
    v_and_b32 v2, 15, v0
    v_mul_u32_u24 v2, 160, v2
    v_lshrrev_b32 v3, 4, v0
    v_lshlrev_b32 v3, 3, v3
    v_add3_u32 v5, v2, v3, s77
    v_add_u32 v6, s77, v1
    s_lshl_b32 s76, s71, 6
    s_lshl_b32 s78, s69, 4
    s_add_u32 s76, s76, s78
    s_mul_i32 s76, s76, 2560
    s_mul_i32 s78, s72, 160
    s_add_u32 s76, s76, s78
    s_add_u32 s76, s76, 1280
    v_add_u32 v2, 0, v0
    v_mul_u32_u24 v3, 0x199a, v2
    v_lshrrev_b32 v3, 16, v3
    v_mul_u32_u24 v3, 1280, v3
    v_add_u32 v40, v3, v161
    v_add_u32 v2, 64, v0
    v_mul_u32_u24 v3, 0x199a, v2
    v_lshrrev_b32 v3, 16, v3
    v_mul_u32_u24 v3, 1280, v3
    v_add_u32 v41, v3, v162
    v_add_u32 v2, 128, v0
    v_mul_u32_u24 v3, 0x199a, v2
    v_lshrrev_b32 v3, 16, v3
    v_mul_u32_u24 v3, 1280, v3
    v_add_u32 v42, v3, v163
    s_waitcnt vmcnt(0)
    ds_read_b64_tr_b16 v[16:17], v4 offset:0
    ds_read_b64_tr_b16 v[18:19], v4 offset:512
    ds_read_b64_tr_b16 v[20:21], v4 offset:1024
    ds_read_b64_tr_b16 v[22:23], v4 offset:1536
    ds_read_b64_tr_b16 v[24:25], v4 offset:2048
    s_waitcnt lgkmcnt(0)
    ds_write_b64 v5, v[16:17] offset:0
    ds_write_b64 v5, v[18:19] offset:32
    ds_write_b64 v5, v[20:21] offset:64
    ds_write_b64 v5, v[22:23] offset:96
    ds_write_b64 v5, v[24:25] offset:128
    ds_read_b128 v[28:31], v6 offset:0
    ds_read_b128 v[32:35], v6 offset:1024
    ds_read_b128 v[36:39], v6 offset:2048
    s_waitcnt lgkmcnt(2)
    buffer_store_dwordx4 v[28:31], v40, s[60:63], s76 offen
    s_waitcnt lgkmcnt(1)
    buffer_store_dwordx4 v[32:35], v41, s[60:63], s76 offen
    s_waitcnt lgkmcnt(0)
    s_mov_b32 exec_hi, 0
    buffer_store_dwordx4 v[36:39], v42, s[60:63], s76 offen
    s_mov_b32 exec_hi, -1
    s_barrier
    s_endpgm
L_stage_all:
    s_and_b32 s88, s98, 1
    s_mul_i32 s88, s88, -81920
    s_add_u32 s88, s88, 81920
    s_mul_i32 s89, s98, 21504
    s_add_u32 s89, s89, 73728
    s_add_u32 s84, s69, 0
    s_lshl_b32 s84, s84, 10
    s_add_u32 m0, s84, s88
    s_add_u32 s84, s84, s89
    buffer_load_dwordx4 v1, s[56:59], s84 offen sc1 lds
    s_add_u32 s84, s69, 4
    s_lshl_b32 s84, s84, 10
    s_add_u32 m0, s84, s88
    s_add_u32 s84, s84, s89
    buffer_load_dwordx4 v1, s[56:59], s84 offen sc1 lds
    s_add_u32 s84, s69, 8
    s_lshl_b32 s84, s84, 10
    s_add_u32 m0, s84, s88
    s_add_u32 s84, s84, s89
    buffer_load_dwordx4 v1, s[56:59], s84 offen sc1 lds
    s_add_u32 s84, s69, 12
    s_lshl_b32 s84, s84, 10
    s_add_u32 m0, s84, s88
    s_add_u32 s84, s84, s89
    buffer_load_dwordx4 v1, s[56:59], s84 offen sc1 lds
    s_add_u32 s84, s69, 16
    s_lshl_b32 s84, s84, 10
    s_add_u32 m0, s84, s88
    s_add_u32 s84, s84, s89
    buffer_load_dwordx4 v1, s[56:59], s84 offen sc1 lds
    s_add_u32 s84, s69, 20
    s_cmp_ge_u32 s84, 21
    s_cselect_b32 s85, 64512, 0
    s_lshl_b32 s84, s84, 10
    s_add_u32 m0, s84, s88
    s_add_u32 s84, s84, s85
    s_add_u32 s84, s84, s89
    buffer_load_dwordx4 v1, s[56:59], s84 offen sc1 lds
    s_add_u32 s84, s69, 24
    s_lshl_b32 s84, s84, 10
    s_add_u32 m0, s84, s88
    s_add_u32 s84, s84, s89
    s_add_u32 s84, s84, 64512
    buffer_load_dwordx4 v1, s[56:59], s84 offen sc1 lds
    s_add_u32 s84, s69, 28
    s_lshl_b32 s84, s84, 10
    s_add_u32 m0, s84, s88
    s_add_u32 s84, s84, s89
    s_add_u32 s84, s84, 64512
    buffer_load_dwordx4 v1, s[56:59], s84 offen sc1 lds
    s_add_u32 s84, s69, 32
    s_lshl_b32 s84, s84, 10
    s_add_u32 m0, s84, s88
    s_add_u32 s84, s84, s89
    s_add_u32 s84, s84, 64512
    buffer_load_dwordx4 v1, s[56:59], s84 offen sc1 lds
    s_add_u32 s84, s69, 36
    s_lshl_b32 s84, s84, 10
    s_add_u32 m0, s84, s88
    s_add_u32 s84, s84, s89
    s_add_u32 s84, s84, 64512
    buffer_load_dwordx4 v1, s[56:59], s84 offen sc1 lds
    s_add_u32 s84, s69, 40
    s_min_u32 s84, s84, 41
    s_lshl_b32 s84, s84, 10
    s_add_u32 m0, s84, s88
    s_add_u32 s84, s84, s89
    s_add_u32 s84, s84, 64512
    buffer_load_dwordx4 v1, s[56:59], s84 offen sc1 lds
    s_setpc_b64 s[90:91]
L_codeend:
    s_endpgm
.section .rodata,"a"
.p2align 6
.amdhsa_kernel concat_heads__grouped_kv_mqa__ssm_conv_s4d__prompt_kernel
  .amdhsa_next_free_vgpr 168
  .amdhsa_next_free_sgpr 102
  .amdhsa_accum_offset 168
  .amdhsa_group_segment_fixed_size 0
  .amdhsa_kernarg_size 120
  .amdhsa_user_sgpr_count 2
  .amdhsa_user_sgpr_kernarg_segment_ptr 1
  .amdhsa_system_sgpr_workgroup_id_x 1
  .amdhsa_float_denorm_mode_32 3
.end_amdhsa_kernel
```
